```python
import torch

def _softmax(x, axis=-1):
    return torch.softmax(x, dim=axis)
def _gelu(x):
    return torch.nn.functional.gelu(x, approximate="tanh")
def _silu(x):
    return torch.nn.functional.silu(x)
def _sigmoid(x):
    return torch.sigmoid(x)
def _layernorm(x, axis=-1, eps=1e-5):
    m = x.mean(dim=axis, keepdim=True)
    v = x.var(dim=axis, keepdim=True, unbiased=False)
    return (x - m) / torch.sqrt(v + eps)
def _scatter_add(tgt, idx, src, axis=0):
    return tgt.clone().index_add_(axis, idx, src)
def _segment_sum(src, seg, n):
    out = torch.zeros((n,) + src.shape[1:], dtype=src.dtype)
    return out.index_add_(0, seg, src)
def _pad(x, pw):
    flat = tuple(v for pair in reversed(pw) for v in pair)
    return torch.nn.functional.pad(x, flat)

kernel_name = 'standalone__attention_interact_autoint__recsys'

def setup_inputs():

    _w = (lambda a: (lambda t: t.to(torch.bfloat16) if t.is_floating_point() else t)(torch.as_tensor(a)))
    B, F = 4096, 100
    D = max(2, (64 // 2) * 2)
    H = 2
    Dh = D // H
    return {
        "e": _w((lambda *s: torch.randn(*s, dtype=torch.bfloat16) * 0.05)(B, F, D).to(float)),
        "wq": _w((lambda *s: torch.randn(*s, dtype=torch.bfloat16) * 3.2)(H, D, Dh).to(float)),
        "wk": _w((lambda *s: torch.randn(*s, dtype=torch.bfloat16) * 3.2)(H, D, Dh).to(float)),
        "wv": _w((lambda *s: torch.randn(*s, dtype=torch.bfloat16) * 0.05)(H, D, Dh).to(float)),
        "wres": _w((lambda *s: torch.randn(*s, dtype=torch.bfloat16) * 0.05)(D, D).to(float)),
    }

def reference(e, wq, wk, wv, wres):
    H, D, Dh = wq.shape[0], wq.shape[1], wq.shape[2]
    B, F = e.shape[0], e.shape[1]
    q = torch.einsum('bfd,hdk->bhfk', e, wq)
    k = torch.einsum('bfd,hdk->bhfk', e, wk)
    v = torch.einsum('bfd,hdk->bhfk', e, wv)
    scale = float(Dh) ** -0.5
    scores = torch.einsum('bhfk,bhgk->bhfg', q, k) * scale
    attn = _softmax(scores, axis=-1)
    attn = (lambda x, dt: x.to(dt))(attn, v.dtype)
    ctx = torch.einsum('bhfg,bhgk->bhfk', attn, v)
    ctx = (lambda x, *d: x.permute(*d))(ctx, 0, 2, 1, 3).reshape(B, F, H * Dh)
    res = torch.einsum('bfd,de->bfe', e, wres)
    out = ctx + res
    mask = (lambda x, dt: x.to(dt))(out > 0, out.dtype)
    return out * mask
```

```asm
; @launch grid=(256,1,1) block=(256,1,1) lds=139264
.amdgcn_target "amdgcn-amd-amdhsa--gfx950"
.text
.globl standalone__attention_interact_autoint__recsys_kernel
.p2align 8
.type standalone__attention_interact_autoint__recsys_kernel,@function
standalone__attention_interact_autoint__recsys_kernel:
    s_cmp_ge_u32 s2, 256
    s_cbranch_scc1 L_end
    s_load_dwordx4 s[4:7], s[0:1], 0
    s_load_dwordx4 s[8:11], s[0:1], 16
    s_load_dwordx4 s[12:15], s[0:1], 32
    s_and_b32 s3, s2, 7
    s_lshl_b32 s3, s3, 5
    s_lshr_b32 s21, s2, 3
    s_add_u32 s3, s3, s21
    v_lshrrev_b32 v2, 6, v0
    v_and_b32 v1, 63, v0
    v_readfirstlane_b32 s20, v2
    s_getpc_b64 s[16:17]
    s_lshr_b32 s21, s2, 3
    s_and_b32 s21, s21, 3
    s_mul_i32 s21, s21, 4096
    s_add_u32 s16, s16, s21
    s_addc_u32 s17, s17, 0
    v_lshlrev_b32 v100, 4, v0
    v_mov_b32 v101, s17
    v_add_co_u32 v100, vcc, s16, v100
    s_nop 1
    v_addc_co_u32 v101, vcc, 0, v101, vcc
    global_load_dwordx4 a[224:227], v[100:101], off
    v_and_b32 v6, 7, v1
    v_lshrrev_b32 v7, 3, v1
    v_and_b32 v8, 3, v1
    v_bfe_u32 v9, v1, 2, 1
    v_bfe_u32 v10, v1, 3, 1
    v_bfe_u32 v11, v1, 4, 1
    v_lshrrev_b32 v12, 5, v1
    s_lshl_b32 s40, s3, 4
    s_lshl_b32 s21, s20, 2
    s_add_u32 s40, s40, s21
    s_mul_i32 s40, s40, 12800
    s_mul_i32 s42, s20, 34816
    v_bfe_u32 v28, v1, 1, 2
    v_lshl_add_u32 v15, v11, 2, v28
    v_and_b32 v29, 1, v1
    v_lshl_add_u32 v30, v10, 1, v29
    s_cmp_eq_u32 s20, 3
    s_cselect_b32 s36, 128, 64
    s_cselect_b32 s37, 64, 4096
    s_lshl_b32 s38, s36, 3
    v_mul_lo_u32 v4, v15, s38
    v_lshl_add_u32 v4, v30, 4, v4
    v_mul_lo_u32 v5, v12, s37
    v_add_u32 v4, v4, v5
    v_lshlrev_b32 v128, 7, v6
    v_xor_b32 v3, 1, v7
    v_lshl_add_u32 v129, v3, 4, v128
    v_lshl_add_u32 v128, v7, 4, v128
    v_and_b32 v27, 31, v1
    v_mul_u32_u24 v13, 12800, v12
    v_lshl_add_u32 v13, v27, 4, v13
    v_bfe_u32 v14, v1, 3, 2
    v_xor_b32 v3, v12, v11
    v_lshlrev_b32 v127, 10, v14
    v_lshl_add_u32 v130, v12, 7, v127
    v_lshl_add_u32 v127, v3, 7, v127
    v_lshl_add_u32 v127, v6, 4, v127
    v_add_u32 v127, s42, v127
    v_lshl_add_u32 v130, v6, 4, v130
    v_add_u32 v130, s42, v130
    v_lshlrev_b32 v104, 4, v1
    v_add_u32 v131, s42, v104
    v_mov_b32 v107, v104
    v_lshlrev_b32 v3, 4, v12
    v_xor_b32 v104, v104, v3
    v_xor_b32 v108, 32, v104
    v_add_u32 v105, 69632, v104
    v_add_u32 v109, 69632, v108
    s_add_u32 s45, s42, 24576
    s_mov_b32 s50, 0xff00ff00
    s_mov_b32 s51, 0xff00ff00
    s_mov_b32 s52, 0x00000f0f
    s_mov_b32 s53, 0x00000f0f
    s_mov_b32 s54, 0x5f800000
    s_mov_b32 s59, 0x00020000
    v_mov_b32 v16, 0x40000
    v_lshlrev_b32 v17, 5, v8
    v_lshl_add_u32 v18, v12, 4, v17
    v_add_u32 v18, s45, v18
    v_cmp_eq_u32 vcc, v9, v11
    s_nop 1
    v_cndmask_b32 v18, v16, v18, vcc
    v_cndmask_b32 v139, v18, v16, s[50:51]
    v_cndmask_b32 v133, v16, v18, s[50:51]
    v_lshl_add_u32 v137, v10, 7, v18
    v_add_u32 v137, 8192, v137
    v_lshlrev_b32 v19, 3, v12
    v_sub_u32 v159, v137, v19
    v_lshlrev_b32 v19, 9, v10
    v_lshl_add_u32 v19, v8, 7, v19
    v_lshl_add_u32 v19, v12, 4, v19
    v_add_u32 v19, s42, v19
    v_cndmask_b32 v106, v16, v19, vcc
    v_and_b32 v19, 1, v1
    v_lshl_add_u32 v19, v10, 1, v19
    v_lshlrev_b32 v19, 5, v19
    v_lshl_add_u32 v19, v12, 4, v19
    v_add_u32 v19, s45, v19
    v_cndmask_b32 v19, v16, v19, vcc
    v_bfe_u32 v20, v1, 1, 1
    v_cmp_eq_u32 s[22:23], 0, v20
    s_nop 1
    v_cndmask_b32 v132, v16, v19, s[22:23]
    s_waitcnt lgkmcnt(0)
    s_mov_b32 s32, s6
    s_mov_b32 s33, s7
    s_cmp_eq_u32 s20, 1
    s_cselect_b32 s32, s8, s32
    s_cselect_b32 s33, s9, s33
    s_cmp_eq_u32 s20, 2
    s_cselect_b32 s32, s10, s32
    s_cselect_b32 s33, s11, s33
    s_cmp_eq_u32 s20, 3
    s_cselect_b32 s32, s12, s32
    s_cselect_b32 s33, s13, s33
    s_mov_b32 s34, 8192
    s_mov_b32 s35, 0x00020000
    s_mov_b32 s37, 0
    buffer_load_dwordx4 v[160:163], v4, s[32:35], s37 offen
    s_add_u32 s37, s37, s36
    buffer_load_dwordx4 v[164:167], v4, s[32:35], s37 offen
    s_add_u32 s37, s37, s36
    buffer_load_dwordx4 v[168:171], v4, s[32:35], s37 offen
    s_add_u32 s37, s37, s36
    buffer_load_dwordx4 v[172:175], v4, s[32:35], s37 offen
    s_add_u32 s37, s37, s36
    buffer_load_dwordx4 v[176:179], v4, s[32:35], s37 offen
    s_add_u32 s37, s37, s36
    buffer_load_dwordx4 v[180:183], v4, s[32:35], s37 offen
    s_add_u32 s37, s37, s36
    buffer_load_dwordx4 v[184:187], v4, s[32:35], s37 offen
    s_add_u32 s37, s37, s36
    buffer_load_dwordx4 v[188:191], v4, s[32:35], s37 offen
    s_mov_b32 s24, s4
    s_mov_b32 s25, s5
    s_mov_b32 s26, 52428800
    s_mov_b32 s27, 0x00020000
    s_mov_b32 s28, s14
    s_mov_b32 s29, s15
    s_mov_b32 s30, 52428800
    s_mov_b32 s31, 0x00020000
    s_add_u32 m0, s42, 0
    s_add_u32 s43, s40, 0
    buffer_load_dwordx4 v128, s[24:27], s43 offen offset:0 nt lds
    v_mov_b32 v19, 0x3f803f80
    v_cndmask_b32 v20, 0, v19, vcc
    v_cmp_eq_u32 s[22:23], 0, v8
    s_nop 1
    v_cndmask_b32 v20, 0, v20, s[22:23]
    v_cndmask_b32 v21, 0, v19, s[22:23]
    v_accvgpr_write_b32 a248, v20
    v_accvgpr_write_b32 a254, v21
    buffer_load_dwordx4 v128, s[24:27], s43 offen offset:1024 nt lds
    v_accvgpr_write_b32 a249, v20
    v_accvgpr_write_b32 a255, v21
    v_cmp_eq_u32 vcc, 0, v9
    s_nop 1
    v_cndmask_b32 v20, 0, v19, vcc
    v_xor_b32 v21, v19, v20
    v_accvgpr_write_b32 a240, v20
    v_accvgpr_write_b32 a244, v19
    buffer_load_dwordx4 v129, s[24:27], s43 offen offset:2048 nt lds
    v_accvgpr_write_b32 a241, v20
    v_accvgpr_write_b32 a245, v19
    v_accvgpr_write_b32 a242, v21
    v_accvgpr_write_b32 a246, v19
    v_accvgpr_write_b32 a243, v21
    v_accvgpr_write_b32 a247, v19
    v_mov_b32 v20, 0x44444444
    buffer_load_dwordx4 v129, s[24:27], s43 offen offset:3072 nt lds
    v_mov_b32 v21, 0xeeeeeeee
    v_cndmask_b32 v158, v21, v20, s[22:23]
    v_lshlrev_b32 v21, 3, v27
    v_add_u32 v21, s45, v21
    v_lshl_add_u32 v134, v12, 2, v21
    v_lshl_add_u32 v124, v12, 11, v21
    v_mov_b32 v19, 0
    s_add_u32 m0, s42, 32768
    s_add_u32 s43, s40, 12288
    buffer_load_dwordx4 v13, s[24:27], s43 offen nt lds
    v_accvgpr_write_b32 a251, v19
    v_accvgpr_write_b32 a253, v19
    v_lshlrev_b32 v23, 4, v11
    v_lshl_add_u32 v23, v12, 3, v23
    v_add_u32 v24, v23, v17
    v_lshl_add_u32 v25, v9, 7, v24
    v_add_u32 v25, s45, v25
    s_add_u32 m0, s42, 33792
    s_add_u32 s43, s40, 37888
    buffer_load_dwordx4 v13, s[24:27], s43 offen nt lds
    v_lshl_add_u32 v135, v10, 8, v25
    v_lshl_add_u32 v125, v10, 11, v25
    v_lshl_add_u32 v136, v9, 8, v24
    v_lshl_add_u32 v136, v10, 7, v136
    v_add_u32 v136, s45, v136
    v_add_u32 v136, 8192, v136
    v_lshl_add_u32 v138, v8, 7, v23
    s_add_u32 m0, s42, 4096
    s_add_u32 s43, s40, 4096
    buffer_load_dwordx4 v128, s[24:27], s43 offen offset:0 nt lds
    v_lshl_add_u32 v138, v10, 6, v138
    v_lshl_add_u32 v138, v9, 5, v138
    v_mov_b32 v126, 0
    v_lshlrev_b32 v5, 12, v12
    v_lshl_add_u32 v5, v15, 9, v5
    v_lshl_add_u32 v5, v10, 8, v5
    v_lshl_add_u32 v5, v29, 6, v5
    buffer_load_dwordx4 v128, s[24:27], s43 offen offset:1024 nt lds
    v_add_u32 v5, s42, v5
    v_lshl_add_u32 v44, v28, 4, v5
    v_xor_b32 v45, 16, v44
    v_xor_b32 v46, 32, v44
    v_xor_b32 v47, 48, v44
    s_lshl_b32 s21, s20, 10
    v_add_u32 v107, s21, v107
    buffer_load_dwordx4 v129, s[24:27], s43 offen offset:2048 nt lds
    s_mov_b32 s21, 0x05040100
    s_mov_b32 s22, 0x07060302
    s_mov_b32 s39, 0x3e8293ee
    v_mov_b32 v116, 1.0
    v_mov_b32 v252, 0
    v_mov_b32 v117, 1.0
    v_mov_b32 v253, 0
    buffer_load_dwordx4 v129, s[24:27], s43 offen offset:3072 nt lds
    v_mov_b32 v118, 1.0
    v_mov_b32 v254, 0
    v_mov_b32 v119, 1.0
    v_mov_b32 v255, 0
    s_waitcnt vmcnt(16)
    v_perm_b32 v64, v164, v160, s21
    v_perm_b32 v68, v164, v160, s22
    v_perm_b32 v72, v165, v161, s21
    v_perm_b32 v76, v165, v161, s22
    v_perm_b32 v80, v166, v162, s21
    v_perm_b32 v84, v166, v162, s22
    v_perm_b32 v88, v167, v163, s21
    v_perm_b32 v92, v167, v163, s22
    s_waitcnt vmcnt(14)
    v_perm_b32 v65, v172, v168, s21
    v_perm_b32 v69, v172, v168, s22
    v_perm_b32 v73, v173, v169, s21
    v_perm_b32 v77, v173, v169, s22
    v_perm_b32 v81, v174, v170, s21
    v_perm_b32 v85, v174, v170, s22
    v_perm_b32 v89, v175, v171, s21
    v_perm_b32 v93, v175, v171, s22
    s_waitcnt vmcnt(12)
    v_perm_b32 v66, v180, v176, s21
    v_perm_b32 v70, v180, v176, s22
    v_perm_b32 v74, v181, v177, s21
    v_perm_b32 v78, v181, v177, s22
    v_perm_b32 v82, v182, v178, s21
    v_perm_b32 v86, v182, v178, s22
    v_perm_b32 v90, v183, v179, s21
    v_perm_b32 v94, v183, v179, s22
    s_waitcnt vmcnt(10)
    v_perm_b32 v67, v188, v184, s21
    v_perm_b32 v71, v188, v184, s22
    v_perm_b32 v75, v189, v185, s21
    v_perm_b32 v79, v189, v185, s22
    v_perm_b32 v83, v190, v186, s21
    v_perm_b32 v87, v190, v186, s22
    v_perm_b32 v91, v191, v187, s21
    v_perm_b32 v95, v191, v187, s22
    ds_write_b128 v44, v[64:67] offset:12288
    ds_write_b128 v45, v[68:71] offset:12288
    ds_write_b128 v46, v[72:75] offset:12288
    ds_write_b128 v47, v[76:79] offset:12288
    ds_write_b128 v44, v[80:83] offset:12416
    ds_write_b128 v45, v[84:87] offset:12416
    ds_write_b128 v46, v[88:91] offset:12416
    ds_write_b128 v47, v[92:95] offset:12416
    s_add_u32 m0, s42, 8192
    s_add_u32 s43, s40, 8192
    buffer_load_dwordx4 v128, s[24:27], s43 offen offset:0 nt lds
    buffer_load_dwordx4 v128, s[24:27], s43 offen offset:1024 nt lds
    buffer_load_dwordx4 v129, s[24:27], s43 offen offset:2048 nt lds
    buffer_load_dwordx4 v129, s[24:27], s43 offen offset:3072 nt lds
    s_waitcnt lgkmcnt(0)
    s_barrier
L_main:
    ds_read_b128 a[32:35], v104 offset:47104
    v_mov_b32 v0, 0
    v_mov_b32 v1, 0
    v_mov_b32 v2, 0
    v_mov_b32 v3, 0
    v_mov_b32 v4, 0
    v_mov_b32 v5, 0
    v_mov_b32 v6, 0
    v_mov_b32 v7, 0
    v_mov_b32 v8, 0
    v_mov_b32 v9, 0
    v_mov_b32 v10, 0
    v_mov_b32 v11, 0
    v_mov_b32 v12, 0
    v_mov_b32 v13, 0
    v_mov_b32 v14, 0
    v_mov_b32 v15, 0
    v_mov_b32 v48, 0
    v_mov_b32 v49, 0
    v_mov_b32 v50, 0
    v_mov_b32 v51, 0
    v_mov_b32 v52, 0
    v_mov_b32 v53, 0
    v_mov_b32 v54, 0
    v_mov_b32 v55, 0
    s_mov_b32 s47, 0x40000000
    ds_read_b128 a[36:39], v108 offset:48128
    s_add_u32 s48, s40, 12800
    s_add_u32 s49, s40, 25600
    ds_read_b128 a[40:43], v104 offset:49152
    s_add_u32 m0, s42, 0
    s_add_u32 s43, s48, 0
    ds_read_b128 a[44:47], v108 offset:50176
    s_mov_b32 s45, 0
    s_waitcnt vmcnt(10)
    ds_read_b128 a[128:131], v127 offset:0
    ds_read_b128 a[132:135], v127 offset:256
    ds_read_b128 a[136:139], v127 offset:512
    ds_read_b128 a[140:143], v127 offset:768
    ds_read_b128 a[64:67], v105 offset:12288
    ds_read_b128 a[68:71], v109 offset:13312
    ds_read_b128 a[72:75], v105 offset:14336
    ds_read_b128 a[76:79], v109 offset:15360
    s_waitcnt lgkmcnt(7)
    v_mfma_f32_32x32x16_bf16 v[80:95], a[32:35], a[128:131], 0
    ds_read_b128 v[32:35], v107 offset:12288
    ds_read_b128 v[36:39], v107 offset:16384
    s_waitcnt lgkmcnt(8)
    v_mfma_f32_32x32x16_bf16 v[80:95], a[36:39], a[132:135], v[80:95]
    s_waitcnt lgkmcnt(7)
    s_waitcnt vmcnt(8)
    ds_read_b128 a[192:195], v106 offset:32768
    s_waitcnt lgkmcnt(7)
    buffer_load_dwordx4 v128, s[24:27], s43 offen offset:0 nt lds
    ds_read_b128 a[196:199], v106 offset:32800
    v_mfma_f32_32x32x16_bf16 v[80:95], a[40:43], a[136:139], v[80:95]
    s_waitcnt lgkmcnt(7)
    ds_read_b128 a[200:203], v106 offset:32832
    ds_read_b128 a[204:207], v106 offset:32864
    v_mfma_f32_32x32x16_bf16 v[80:95], a[44:47], a[140:143], v[80:95]
    s_waitcnt lgkmcnt(7)
    ds_read_b128 a[48:51], v104 offset:51200
    ds_read_b128 a[52:55], v108 offset:52224
    v_mfma_f32_32x32x16_bf16 v[64:79], a[128:131], a[64:67], 0
    s_waitcnt lgkmcnt(8)
    ds_read_b128 a[56:59], v104 offset:53248
    s_waitcnt lgkmcnt(8)
    v_lshlrev_b32 v40, 16, v32
    v_and_b32 v41, 0xffff0000, v32
    v_mul_f32 v40, s39, v40
    v_mul_f32 v41, s39, v41
    v_mfma_f32_32x32x16_bf16 v[64:79], a[132:135], a[68:71], v[64:79]
    s_waitcnt lgkmcnt(7)
    ds_read_b128 a[60:63], v108 offset:54272
    v_cvt_pk_bf16_f32 v32, v40, v41
    v_lshlrev_b32 v40, 16, v33
    v_and_b32 v41, 0xffff0000, v33
    v_mul_f32 v40, s39, v40
    v_mul_f32 v41, s39, v41
    v_mfma_f32_32x32x16_bf16 v[64:79], a[136:139], a[72:75], v[64:79]
    s_waitcnt lgkmcnt(6)
    ds_read_b128 a[80:83], v105 offset:16384
    v_cvt_pk_bf16_f32 v33, v40, v41
    v_lshlrev_b32 v40, 16, v34
    v_and_b32 v41, 0xffff0000, v34
    v_mul_f32 v40, s39, v40
    v_mul_f32 v41, s39, v41
    v_mfma_f32_32x32x16_bf16 v[64:79], a[140:143], a[76:79], v[64:79]
    s_waitcnt lgkmcnt(5)
    ds_read_b128 a[84:87], v109 offset:17408
    v_cvt_pk_bf16_f32 v34, v40, v41
    v_lshlrev_b32 v40, 16, v35
    v_and_b32 v41, 0xffff0000, v35
    v_mul_f32 v40, s39, v40
    v_mul_f32 v41, s39, v41
    v_mfma_f32_16x16x32_bf16 v[192:195], a[32:35], a[192:195], 0
    s_waitcnt lgkmcnt(4)
    ds_read_b128 a[88:91], v105 offset:18432
    v_cvt_pk_bf16_f32 v35, v40, v41
    v_mfma_f32_16x16x32_bf16 v[192:195], a[36:39], a[196:199], v[192:195]
    s_waitcnt lgkmcnt(4)
    ds_read_b128 a[92:95], v109 offset:19456
    v_lshlrev_b32 v40, 16, v36
    v_mfma_f32_16x16x32_bf16 v[192:195], a[40:43], a[200:203], v[192:195]
    ds_write_b128 v107, v[32:35] offset:12288
    v_mfma_f32_16x16x32_bf16 v[192:195], a[44:47], a[204:207], v[192:195]
    s_waitcnt lgkmcnt(5)
    v_and_b32 v41, 0xffff0000, v36
    v_mul_f32 v40, s39, v40
    v_mfma_f32_16x16x32_bf16 v[196:199], a[48:51], a[192:195], 0
    s_waitcnt lgkmcnt(4)
    v_mul_f32 v41, s39, v41
    v_cvt_pk_bf16_f32 v36, v40, v41
    v_mfma_f32_16x16x32_bf16 v[196:199], a[52:55], a[196:199], v[196:199]
    v_lshlrev_b32 v40, 16, v37
    v_and_b32 v41, 0xffff0000, v37
    v_mfma_f32_16x16x32_bf16 v[196:199], a[56:59], a[200:203], v[196:199]
    s_waitcnt lgkmcnt(3)
    v_mul_f32 v40, s39, v40
    v_mul_f32 v41, s39, v41
    v_mfma_f32_16x16x32_bf16 v[196:199], a[60:63], a[204:207], v[196:199]
    v_cvt_pk_bf16_f32 v37, v40, v41
    v_lshlrev_b32 v40, 16, v38
    v_mfma_f32_16x16x32_bf16 v[200:203], a[192:195], a[64:67], 0
    s_waitcnt lgkmcnt(2)
    v_and_b32 v41, 0xffff0000, v38
    v_mul_f32 v40, s39, v40
    v_mfma_f32_16x16x32_bf16 v[200:203], a[196:199], a[68:71], v[200:203]
    s_waitcnt lgkmcnt(1)
    v_mul_f32 v41, s39, v41
    v_cvt_pk_bf16_f32 v38, v40, v41
    v_mfma_f32_16x16x32_bf16 v[200:203], a[200:203], a[72:75], v[200:203]
    s_waitcnt lgkmcnt(0)
    v_lshlrev_b32 v40, 16, v39
    v_and_b32 v41, 0xffff0000, v39
    v_mfma_f32_16x16x32_bf16 v[200:203], a[204:207], a[76:79], v[200:203]
    v_mul_f32 v40, s39, v40
    v_mul_f32 v41, s39, v41
    v_mfma_f32_16x16x32_bf16 v[204:207], a[192:195], a[80:83], 0
    v_cvt_pk_bf16_f32 v39, v40, v41
    v_cvt_pk_bf16_f32 v160, v80, v81
    v_mfma_f32_16x16x32_bf16 v[204:207], a[196:199], a[84:87], v[204:207]
    ds_write_b128 v107, v[36:39] offset:16384
    v_mfma_f32_16x16x32_bf16 v[204:207], a[200:203], a[88:91], v[204:207]
    s_waitcnt lgkmcnt(0)
    s_barrier
    s_waitcnt vmcnt(5)
    ds_read_b128 a[144:147], v127 offset:4096
    v_mfma_f32_16x16x32_bf16 v[204:207], a[204:207], a[92:95], v[204:207]
    v_cvt_pk_bf16_f32 v161, v82, v83
    v_cvt_pk_bf16_f32 v162, v84, v85
    v_cvt_pk_bf16_f32 v163, v86, v87
    v_cvt_pk_bf16_f32 v164, v88, v89
    v_cvt_pk_bf16_f32 v165, v90, v91
    v_cvt_pk_bf16_f32 v166, v92, v93
    v_cvt_pk_bf16_f32 v167, v94, v95
    v_cvt_pk_bf16_f32 v208, v64, v65
    v_cvt_pk_bf16_f32 v209, v66, v67
    v_cvt_pk_bf16_f32 v210, v68, v69
    v_cvt_pk_bf16_f32 v211, v70, v71
    v_cvt_pk_bf16_f32 v212, v72, v73
    v_cvt_pk_bf16_f32 v213, v74, v75
    v_cvt_pk_bf16_f32 v214, v76, v77
    v_cvt_pk_bf16_f32 v215, v78, v79
    v_cvt_pk_bf16_f32 v192, v192, v193
    v_cvt_pk_bf16_f32 v193, v194, v195
    v_cvt_pk_bf16_f32 v196, v196, v197
    v_cvt_pk_bf16_f32 v197, v198, v199
    v_cvt_pk_bf16_f32 v200, v200, v201
    v_cvt_pk_bf16_f32 v201, v202, v203
    v_cvt_pk_bf16_f32 v204, v204, v205
    v_cvt_pk_bf16_f32 v205, v206, v207
    ds_read_b128 a[148:151], v127 offset:4352
    buffer_load_dwordx4 v128, s[24:27], s43 offen offset:1024 nt lds
    s_waitcnt lgkmcnt(1)
    v_mfma_f32_32x32x16_bf16 v[80:95], a[32:35], a[144:147], 0
    ds_read_b128 a[152:155], v127 offset:4608
    ds_read_b128 a[156:159], v127 offset:4864
    v_mfma_f32_32x32x16_bf16 v[64:79], a[144:147], a[64:67], 0
    ds_read_b128 a[0:3], v104 offset:12288
    ds_read_b128 a[4:7], v108 offset:13312
    ds_read_b128 a[8:11], v104 offset:14336
    ds_read_b128 a[12:15], v108 offset:15360
    ds_read_b128 a[16:19], v104 offset:16384
    s_waitcnt lgkmcnt(7)
    v_mfma_f32_32x32x16_bf16 v[80:95], a[36:39], a[148:151], v[80:95]
    ds_read_b128 a[20:23], v108 offset:17408
    ds_read_b128 a[24:27], v104 offset:18432
    s_waitcnt lgkmcnt(8)
    v_mfma_f32_32x32x16_bf16 v[80:95], a[40:43], a[152:155], v[80:95]
    ds_read_b128 a[28:31], v108 offset:19456
    ds_read_b128 a[96:99], v105 offset:47104
    s_waitcnt lgkmcnt(9)
    v_mfma_f32_32x32x16_bf16 v[80:95], a[44:47], a[156:159], v[80:95]
    s_waitcnt lgkmcnt(8)
    ds_read_b128 a[100:103], v109 offset:48128
    buffer_load_dwordx4 v129, s[24:27], s43 offen offset:2048 nt lds
    ds_read_b128 a[104:107], v105 offset:49152
    v_mfma_f32_32x32x16_bf16 v[64:79], a[148:151], a[68:71], v[64:79]
    s_waitcnt lgkmcnt(8)
    ds_read_b128 a[108:111], v109 offset:50176
    ds_read_b128 a[112:115], v105 offset:51200
    v_mfma_f32_32x32x16_bf16 v[64:79], a[152:155], a[72:75], v[64:79]
    s_waitcnt lgkmcnt(8)
    ds_read_b128 a[116:119], v109 offset:52224
    s_nop 0
    v_cvt_pk_bf16_f32 v168, v80, v81
    v_cvt_pk_bf16_f32 v169, v82, v83
    v_cvt_pk_bf16_f32 v170, v84, v85
    v_cvt_pk_bf16_f32 v171, v86, v87
    v_mfma_f32_32x32x16_bf16 v[64:79], a[156:159], a[76:79], v[64:79]
    s_waitcnt lgkmcnt(7)
    ds_read_b128 a[120:123], v105 offset:53248
    v_cvt_pk_bf16_f32 v172, v88, v89
    v_cvt_pk_bf16_f32 v173, v90, v91
    v_cvt_pk_bf16_f32 v174, v92, v93
    v_cvt_pk_bf16_f32 v175, v94, v95
    v_mfma_f32_16x16x32_bf16 v[184:187], a[0:3], a[192:195], 0
    s_waitcnt lgkmcnt(6)
    ds_read_b128 a[124:127], v109 offset:54272
    v_mfma_f32_16x16x32_bf16 v[184:187], a[4:7], a[196:199], v[184:187]
    s_waitcnt lgkmcnt(6)
    ds_read_b128 a[208:211], v106 offset:33792
    v_cvt_pk_bf16_f32 v216, v64, v65
    v_mfma_f32_16x16x32_bf16 v[184:187], a[8:11], a[200:203], v[184:187]
    s_waitcnt lgkmcnt(6)
    ds_read_b128 a[212:215], v106 offset:33824
    v_cvt_pk_bf16_f32 v217, v66, v67
    v_mfma_f32_16x16x32_bf16 v[184:187], a[12:15], a[204:207], v[184:187]
    s_waitcnt lgkmcnt(6)
    ds_read_b128 a[216:219], v106 offset:33856
    v_cvt_pk_bf16_f32 v218, v68, v69
    v_mfma_f32_16x16x32_bf16 v[188:191], a[16:19], a[192:195], 0
    s_waitcnt lgkmcnt(6)
    ds_read_b128 a[220:223], v106 offset:33888
    v_cvt_pk_bf16_f32 v219, v70, v71
    v_mfma_f32_16x16x32_bf16 v[188:191], a[20:23], a[196:199], v[188:191]
    s_waitcnt lgkmcnt(6)
    ds_write_b64 v125, v[192:193] offset:0
    v_mfma_f32_16x16x32_bf16 v[188:191], a[24:27], a[200:203], v[188:191]
    s_waitcnt lgkmcnt(6)
    v_cvt_pk_bf16_f32 v220, v72, v73
    v_cvt_pk_bf16_f32 v221, v74, v75
    v_mfma_f32_16x16x32_bf16 v[188:191], a[28:31], a[204:207], v[188:191]
    ds_write_b64 v125, v[196:197] offset:256
    v_mfma_f32_16x16x32_bf16 v[140:143], a[96:99], a[192:195], 0
    s_waitcnt lgkmcnt(6)
    v_cvt_pk_bf16_f32 v222, v76, v77
    v_cvt_pk_bf16_f32 v223, v78, v79
    v_mfma_f32_32x32x16_bf16 v[64:79], a[0:3], a[128:131], 0
    s_barrier
    ds_write_b64 v124, v[200:201] offset:1024
    v_cvt_pk_bf16_f32 v184, v184, v185
    v_cvt_pk_bf16_f32 v185, v186, v187
    v_cvt_pk_bf16_f32 v188, v188, v189
    v_mfma_f32_32x32x16_bf16 v[64:79], a[4:7], a[132:135], v[64:79]
    s_waitcnt lgkmcnt(4)
    ds_write_b64 v124, v[204:205] offset:1280
    v_cvt_pk_bf16_f32 v189, v190, v191
    v_mfma_f32_32x32x16_bf16 v[64:79], a[8:11], a[136:139], v[64:79]
    s_waitcnt lgkmcnt(4)
    ds_read_b128 a[176:179], v132 offset:0
    buffer_load_dwordx4 v129, s[24:27], s43 offen offset:3072 nt lds
    ds_read_b128 a[180:183], v132 offset:128
    v_mfma_f32_32x32x16_bf16 v[64:79], a[12:15], a[140:143], v[64:79]
    ds_read_b32 a250, v134 offset:1024
    s_waitcnt vmcnt(4)
    ds_read_b128 a[160:163], v127 offset:8192
    v_mfma_f32_16x16x32_bf16 v[140:143], a[100:103], a[196:199], v[140:143]
    ds_read_b128 a[164:167], v127 offset:8448
    v_mfma_f32_16x16x32_bf16 v[140:143], a[104:107], a[200:203], v[140:143]
    ds_read_b128 a[168:171], v127 offset:8704
    v_mfma_f32_16x16x32_bf16 v[140:143], a[108:111], a[204:207], v[140:143]
    ds_read_b128 a[172:175], v127 offset:8960
    v_mfma_f32_16x16x32_bf16 v[144:147], a[112:115], a[192:195], 0
    ds_write_b64 v125, v[184:185] offset:512
    v_mfma_f32_16x16x32_bf16 v[144:147], a[116:119], a[196:199], v[144:147]
    s_waitcnt lgkmcnt(7)
    v_cvt_pk_bf16_f32 v96, v64, v65
    v_cvt_pk_bf16_f32 v97, v66, v67
    v_mfma_f32_16x16x32_bf16 v[144:147], a[120:123], a[200:203], v[144:147]
    s_waitcnt lgkmcnt(6)
    ds_write_b64 v125, v[188:189] offset:768
    v_mfma_f32_16x16x32_bf16 v[144:147], a[124:127], a[204:207], v[144:147]
    s_waitcnt lgkmcnt(6)
    v_cvt_pk_bf16_f32 v140, v140, v141
    v_cvt_pk_bf16_f32 v141, v142, v143
    v_mfma_f32_16x16x32_bf16 v[240:243], a[32:35], a[208:211], 0
    s_waitcnt lgkmcnt(5)
    ds_write_b64 v125, v[140:141] offset:1536
    v_mfma_f32_16x16x32_bf16 v[240:243], a[36:39], a[212:215], v[240:243]
    s_waitcnt lgkmcnt(5)
    v_cvt_pk_bf16_f32 v144, v144, v145
    v_cvt_pk_bf16_f32 v145, v146, v147
    v_mfma_f32_16x16x32_bf16 v[240:243], a[40:43], a[216:219], v[240:243]
    s_waitcnt lgkmcnt(4)
    ds_write_b64 v125, v[144:145] offset:1792
    v_mfma_f32_16x16x32_bf16 v[240:243], a[44:47], a[220:223], v[240:243]
    s_waitcnt lgkmcnt(4)
    v_cvt_pk_bf16_f32 v98, v68, v69
    v_cvt_pk_bf16_f32 v99, v70, v71
    v_mfma_f32_16x16x32_bf16 v[244:247], a[48:51], a[208:211], 0
    v_cvt_pk_bf16_f32 v100, v72, v73
    v_cvt_pk_bf16_f32 v101, v74, v75
    v_mfma_f32_16x16x32_bf16 v[244:247], a[52:55], a[212:215], v[244:247]
    v_cvt_pk_bf16_f32 v102, v76, v77
    v_cvt_pk_bf16_f32 v103, v78, v79
    v_mfma_f32_16x16x32_bf16 v[244:247], a[56:59], a[216:219], v[244:247]
    v_cvt_pk_bf16_f32 v240, v240, v241
    v_cvt_pk_bf16_f32 v241, v242, v243
    v_mfma_f32_16x16x32_bf16 v[244:247], a[60:63], a[220:223], v[244:247]
    ds_write_b64 v125, v[240:241] offset:4096
    v_mfma_f32_16x16x32_bf16 v[56:59], a[208:211], a[64:67], 0
    v_mov_b32 v64, 0
    v_mov_b32 v65, 0
    v_mfma_f32_16x16x32_bf16 v[56:59], a[212:215], a[68:71], v[56:59]
    v_mov_b32 v66, 0
    v_mov_b32 v67, 0
    v_mfma_f32_16x16x32_bf16 v[56:59], a[216:219], a[72:75], v[56:59]
    v_cvt_pk_bf16_f32 v244, v244, v245
    v_cvt_pk_bf16_f32 v245, v246, v247
    v_mfma_f32_16x16x32_bf16 v[56:59], a[220:223], a[76:79], v[56:59]
    ds_write_b64 v125, v[244:245] offset:4352
    v_mfma_f32_16x16x32_bf16 v[60:63], a[208:211], a[80:83], 0
    v_mov_b32 v68, 0
    v_mov_b32 v69, 0
    v_mfma_f32_16x16x32_bf16 v[60:63], a[212:215], a[84:87], v[60:63]
    v_mov_b32 v70, 0
    v_mov_b32 v71, 0
    v_mfma_f32_16x16x32_bf16 v[60:63], a[216:219], a[88:91], v[60:63]
    v_cvt_pk_bf16_f32 v56, v56, v57
    v_cvt_pk_bf16_f32 v57, v58, v59
    v_mfma_f32_16x16x32_bf16 v[60:63], a[220:223], a[92:95], v[60:63]
    ds_write_b64 v124, v[56:57] offset:5120
    v_mfma_f32_32x32x16_bf16 v[16:31], v[160:163], v[96:99], 0
    v_mov_b32 v72, 0
    v_mov_b32 v73, 0
    v_mov_b32 v74, 0
    v_mov_b32 v75, 0
    v_mov_b32 v76, 0
    v_mov_b32 v77, 0
    v_mfma_f32_32x32x16_bf16 v[16:31], v[164:167], v[100:103], v[16:31]
    v_cvt_pk_bf16_f32 v60, v60, v61
    v_cvt_pk_bf16_f32 v61, v62, v63
    v_mov_b32 v78, 0
    v_mov_b32 v79, 0
    v_mfma_f32_16x16x32_bf16 v[120:123], a[176:179], v[96:99], 0
    ds_write_b64 v124, v[60:61] offset:5376
    v_mfma_f32_16x16x32_bf16 v[120:123], a[180:183], v[100:103], v[120:123]
    v_mfma_f32_16x16x32_bf16 v[232:235], a[0:3], a[208:211], 0
    v_mfma_f32_16x16x32_bf16 v[232:235], a[4:7], a[212:215], v[232:235]
    v_mfma_f32_16x16x32_bf16 v[232:235], a[8:11], a[216:219], v[232:235]
    v_mfma_f32_16x16x32_bf16 v[232:235], a[12:15], a[220:223], v[232:235]
    v_mfma_f32_16x16x32_bf16 v[236:239], a[16:19], a[208:211], 0
    v_mfma_f32_16x16x32_bf16 v[236:239], a[20:23], a[212:215], v[236:239]
    s_nop 1
    v_exp_f32 v120, v120
    v_mfma_f32_16x16x32_bf16 v[236:239], a[24:27], a[216:219], v[236:239]
    v_exp_f32 v121, v121
    v_mfma_f32_16x16x32_bf16 v[236:239], a[28:31], a[220:223], v[236:239]
    v_cvt_pk_bf16_f32 v122, v120, v121
    v_mfma_f32_16x16x32_bf16 v[148:151], a[96:99], a[208:211], 0
    v_cvt_pk_bf16_f32 v232, v232, v233
    v_cvt_pk_bf16_f32 v233, v234, v235
    v_mfma_f32_16x16x32_bf16 v[148:151], a[100:103], a[212:215], v[148:151]
    ds_write_b64 v125, v[232:233] offset:4608
    v_mfma_f32_16x16x32_bf16 v[148:151], a[104:107], a[216:219], v[148:151]
    s_nop 0
    v_cvt_pk_bf16_f32 v236, v236, v237
    v_cvt_pk_bf16_f32 v237, v238, v239
    v_mfma_f32_16x16x32_bf16 v[148:151], a[108:111], a[220:223], v[148:151]
    ds_write_b64 v125, v[236:237] offset:4864
    v_mfma_f32_16x16x32_bf16 v[152:155], a[112:115], a[208:211], 0
    v_mfma_f32_16x16x32_bf16 v[152:155], a[116:119], a[212:215], v[152:155]
    v_mfma_f32_16x16x32_bf16 v[152:155], a[120:123], a[216:219], v[152:155]
    v_mfma_f32_16x16x32_bf16 v[152:155], a[124:127], a[220:223], v[152:155]
    v_mfma_f32_16x16x16_bf16 v[112:115], a[248:249], v[122:123], 0
    s_nop 1
    v_cvt_pk_bf16_f32 v148, v148, v149
    v_cvt_pk_bf16_f32 v149, v150, v151
    ds_write_b64 v125, v[148:149] offset:5632
    s_nop 1
    v_cvt_pk_bf16_f32 v152, v152, v153
    v_cvt_pk_bf16_f32 v153, v154, v155
    ds_write_b64 v125, v[152:153] offset:5888
    s_waitcnt lgkmcnt(0)
.p2align 6
L_loop:
    v_mfma_f32_32x32x16_bf16 v[80:95], a[32:35], a[160:163], 0
    s_add_u32 s44, s47, 4096
    ds_read_b128 a[224:227], v131 offset:16384
    v_exp_f32 v16, v16
    v_exp_f32 v17, v17
    v_exp_f32 v18, v18
    v_mfma_f32_32x32x16_bf16 v[80:95], a[36:39], a[164:167], v[80:95]
    s_cmp_lt_u32 s44, 0x40000000
    ds_read_b128 a[228:231], v131 offset:17408
    v_cvt_pk_bf16_f32 v16, v16, v17
    v_exp_f32 v19, v19
    v_exp_f32 v20, v20
    v_mfma_f32_32x32x16_bf16 v[80:95], a[40:43], a[168:171], v[80:95]
    s_cselect_b32 s58, 4096, 0
    ds_read_b128 a[232:235], v131 offset:18432
    v_cvt_pk_bf16_f32 v17, v18, v19
    v_exp_f32 v21, v21
    v_exp_f32 v22, v22
    v_mfma_f32_32x32x16_bf16 v[80:95], a[44:47], a[172:175], v[80:95]
    s_cselect_b32 s44, s44, 0
    ds_read_b128 a[236:239], v131 offset:19456
    v_cvt_pk_bf16_f32 v18, v20, v21
    v_exp_f32 v23, v23
    v_exp_f32 v24, v24
    v_mfma_f32_32x32x16_bf16 v[0:15], v[252:255], v[52:55], v[0:15]
    s_add_u32 s56, s28, s44
    v_cvt_pk_bf16_f32 v19, v22, v23
    v_exp_f32 v25, v25
    v_exp_f32 v26, v26
    v_cvt_pk_bf16_f32 v20, v24, v25
    v_smfmac_f32_16x16x64_bf16 v[116:119], a[240:243], v[48:55], v158
    s_addc_u32 s57, s29, 0
    s_add_u32 m0, s42, 4096
    v_cvt_pk_bf16_f32 v176, v80, v81
    v_mfma_f32_32x32x16_bf16 v[32:47], v[168:171], v[96:99], 0
    s_add_u32 s43, s48, 4096
    v_exp_f32 v27, v27
    v_exp_f32 v28, v28
    v_cvt_pk_bf16_f32 v21, v26, v27
    v_cvt_pk_bf16_f32 v177, v82, v83
    v_mfma_f32_32x32x16_bf16 v[32:47], v[172:175], v[100:103], v[32:47]
    s_add_u32 s44, s47, 8192
    v_exp_f32 v29, v29
    v_exp_f32 v30, v30
    v_cvt_pk_bf16_f32 v22, v28, v29
    v_exp_f32 v31, v31
    v_cvt_pk_bf16_f32 v178, v84, v85
    v_cvt_pk_bf16_f32 v23, v30, v31
    v_cvt_pk_bf16_f32 v179, v86, v87
    v_cvt_pk_bf16_f32 v180, v88, v89
    v_smfmac_f32_16x16x64_bf16 v[112:115], a[240:243], v[16:23], v158
    s_cmp_lt_u32 s44, 0x40000000
    s_cselect_b32 s44, s44, 0
    v_cvt_pk_bf16_f32 v181, v90, v91
    v_cvt_pk_bf16_f32 v182, v92, v93
    v_cvt_pk_bf16_f32 v183, v94, v95
    v_mfma_f32_32x32x16_bf16 v[80:95], a[160:163], a[64:67], 0
    s_waitcnt lgkmcnt(3)
    buffer_store_dwordx4 a[224:227], v128, s[56:59], 0 offen offset:0 sc0 sc1
    v_add_f32 v116, v116, v117
    v_rcp_f32 v125, v116
    v_exp_f32 v32, v32
    v_max3_u32 v126, v126, v116, v125
    v_pk_fma_f32 v[48:49], v[0:1], v[124:125], v[64:65] op_sel:[0,1,0] op_sel_hi:[1,1,1]
    v_pk_fma_f32 v[50:51], v[2:3], v[124:125], v[66:67] op_sel:[0,1,0] op_sel_hi:[1,1,1]
    v_pk_fma_f32 v[52:53], v[4:5], v[124:125], v[68:69] op_sel:[0,1,0] op_sel_hi:[1,1,1]
    v_pk_fma_f32 v[54:55], v[6:7], v[124:125], v[70:71] op_sel:[0,1,0] op_sel_hi:[1,1,1]
    v_pk_fma_f32 v[56:57], v[8:9], v[124:125], v[72:73] op_sel:[0,1,0] op_sel_hi:[1,1,1]
    v_pk_fma_f32 v[58:59], v[10:11], v[124:125], v[74:75] op_sel:[0,1,0] op_sel_hi:[1,1,1]
    v_pk_fma_f32 v[60:61], v[12:13], v[124:125], v[76:77] op_sel:[0,1,0] op_sel_hi:[1,1,1]
    v_pk_fma_f32 v[62:63], v[14:15], v[124:125], v[78:79] op_sel:[0,1,0] op_sel_hi:[1,1,1]
    v_mfma_f32_32x32x16_bf16 v[80:95], a[164:167], a[68:71], v[80:95]
    s_waitcnt lgkmcnt(0)
    v_cvt_pk_bf16_f32 v48, v48, v49
    v_pk_max_i16 v48, v48, 0
    v_cvt_pk_bf16_f32 v49, v50, v51
    v_pk_max_i16 v49, v49, 0
    v_cvt_pk_bf16_f32 v50, v52, v53
    v_pk_max_i16 v50, v50, 0
    v_mfma_f32_32x32x16_bf16 v[80:95], a[168:171], a[72:75], v[80:95]
    v_cvt_pk_bf16_f32 v51, v54, v55
    v_pk_max_i16 v51, v51, 0
    v_cvt_pk_bf16_f32 v52, v56, v57
    v_pk_max_i16 v52, v52, 0
    v_cvt_pk_bf16_f32 v53, v58, v59
    v_pk_max_i16 v53, v53, 0
    v_mfma_f32_32x32x16_bf16 v[80:95], a[172:175], a[76:79], v[80:95]
    buffer_load_dwordx4 v128, s[24:27], s43 offen offset:0 nt lds
    ds_write_b128 v130, v[48:51] offset:20992
    v_mfma_f32_32x32x16_bf16 v[0:15], v[208:211], v[16:19], 0
    v_cvt_pk_bf16_f32 v54, v60, v61
    v_pk_max_i16 v54, v54, 0
    v_cvt_pk_bf16_f32 v55, v62, v63
    v_pk_max_i16 v55, v55, 0
    v_exp_f32 v33, v33
    v_mfma_f32_32x32x16_bf16 v[0:15], v[212:215], v[20:23], v[0:15]
    ds_write_b128 v130, v[52:55] offset:21248
    v_cvt_pk_bf16_f32 v32, v32, v33
    v_mfma_f32_32x32x16_bf16 v[64:79], a[0:3], a[144:147], 0
    v_exp_f32 v34, v34
    v_exp_f32 v35, v35
    v_exp_f32 v36, v36
    v_mfma_f32_32x32x16_bf16 v[64:79], a[4:7], a[148:151], v[64:79]
    v_cvt_pk_bf16_f32 v33, v34, v35
    v_exp_f32 v37, v37
    v_exp_f32 v38, v38
    v_cvt_pk_bf16_f32 v34, v36, v37
    v_mfma_f32_32x32x16_bf16 v[64:79], a[8:11], a[152:155], v[64:79]
    v_exp_f32 v39, v39
    v_exp_f32 v40, v40
    v_cvt_pk_bf16_f32 v35, v38, v39
    v_cvt_pk_bf16_f32 v224, v80, v81
    v_mfma_f32_32x32x16_bf16 v[64:79], a[12:15], a[156:159], v[64:79]
    v_exp_f32 v41, v41
    v_exp_f32 v42, v42
    v_cvt_pk_bf16_f32 v36, v40, v41
    v_cvt_pk_bf16_f32 v225, v82, v83
    v_mfma_f32_32x32x16_bf16 v[48:63], v[176:179], v[96:99], 0
    buffer_store_dwordx4 a[228:231], v128, s[56:59], 0 offen offset:1024 sc0 sc1
    v_exp_f32 v43, v43
    v_cvt_pk_bf16_f32 v226, v84, v85
    v_mfma_f32_32x32x16_bf16 v[48:63], v[180:183], v[100:103], v[48:63]
    v_cvt_pk_bf16_f32 v37, v42, v43
    v_exp_f32 v44, v44
    v_exp_f32 v45, v45
    v_cvt_pk_bf16_f32 v104, v64, v65
    v_mfma_f32_32x32x16_bf16 v[0:15], v[216:219], v[32:35], v[0:15]
    v_cvt_pk_bf16_f32 v38, v44, v45
    v_exp_f32 v46, v46
    v_exp_f32 v47, v47
    v_cvt_pk_bf16_f32 v105, v66, v67
    v_cvt_pk_bf16_f32 v39, v46, v47
    v_cvt_pk_bf16_f32 v106, v68, v69
    v_cvt_pk_bf16_f32 v107, v70, v71
    v_smfmac_f32_16x16x64_bf16 v[112:115], a[240:243], v[32:39], v158
    v_cvt_pk_bf16_f32 v108, v72, v73
    v_mfma_f32_32x32x16_bf16 v[16:31], v[160:163], v[104:107], 0
    v_cvt_pk_bf16_f32 v109, v74, v75
    v_cvt_pk_bf16_f32 v110, v76, v77
    v_cvt_pk_bf16_f32 v111, v78, v79
    v_cvt_pk_bf16_f32 v227, v86, v87
    v_cvt_pk_bf16_f32 v228, v88, v89
    v_cvt_pk_bf16_f32 v229, v90, v91
    v_mfma_f32_32x32x8_bf16 v[0:15], a[250:251], v[122:123], v[0:15]
    v_cvt_pk_bf16_f32 v230, v92, v93
    v_cvt_pk_bf16_f32 v231, v94, v95
    v_exp_f32 v48, v48
    v_exp_f32 v49, v49
    v_mfma_f32_16x16x32_bf16 v[120:123], a[176:179], v[104:107], 0
    v_cvt_pk_bf16_f32 v48, v48, v49
    v_exp_f32 v50, v50
    v_mfma_f32_16x16x32_bf16 v[120:123], a[180:183], v[108:111], v[120:123]
    v_exp_f32 v51, v51
    v_mfma_f32_32x32x16_bf16 v[64:79], a[96:99], a[128:131], 0
    v_cvt_pk_bf16_f32 v49, v50, v51
    v_exp_f32 v52, v52
    v_exp_f32 v53, v53
    v_exp_f32 v54, v54
    v_mfma_f32_32x32x16_bf16 v[0:15], v[220:223], v[36:39], v[0:15]
    v_cvt_pk_bf16_f32 v50, v52, v53
    v_exp_f32 v55, v55
    v_exp_f32 v120, v120
    v_cvt_pk_bf16_f32 v51, v54, v55
    v_mfma_f32_32x32x16_bf16 v[64:79], a[100:103], a[132:135], v[64:79]
    buffer_load_dwordx4 v128, s[24:27], s43 offen offset:1024 nt lds
    v_exp_f32 v121, v121
    v_exp_f32 v56, v56
    v_mfma_f32_32x32x16_bf16 v[64:79], a[104:107], a[136:139], v[64:79]
    v_cvt_pk_bf16_f32 v122, v120, v121
    v_exp_f32 v57, v57
    v_exp_f32 v58, v58
    v_cvt_pk_bf16_f32 v52, v56, v57
    v_mfma_f32_32x32x16_bf16 v[64:79], a[108:111], a[140:143], v[64:79]
    v_exp_f32 v59, v59
    v_exp_f32 v60, v60
    v_cvt_pk_bf16_f32 v53, v58, v59
    v_exp_f32 v61, v61
    v_mfma_f32_16x16x16_bf16 v[116:119], a[248:249], v[122:123], 0
    v_cvt_pk_bf16_f32 v54, v60, v61
    v_exp_f32 v62, v62
    v_mfma_f32_32x32x16_bf16 v[16:31], v[164:167], v[108:111], v[16:31]
    v_exp_f32 v63, v63
    s_nop 0
    v_cvt_pk_bf16_f32 v55, v62, v63
    v_mfma_f32_32x32x16_bf16 v[0:15], v[224:227], v[48:51], v[0:15]
    ds_read_b128 a[184:187], v132 offset:256
    ds_read_b128 a[188:191], v132 offset:384
    v_mfma_f32_32x32x16_bf16 v[80:95], a[48:51], a[128:131], 0
    ds_read_b32 a252, v134 offset:1280
    ds_read_b128 a[192:195], v139 offset:512
    v_mfma_f32_32x32x16_bf16 v[80:95], a[52:55], a[132:135], v[80:95]
    ds_read_b128 a[196:199], v139 offset:640
    s_nop 0
    v_exp_f32 v16, v16
    v_mfma_f32_32x32x16_bf16 v[80:95], a[56:59], a[136:139], v[80:95]
    v_exp_f32 v17, v17
    v_exp_f32 v18, v18
    v_cvt_pk_bf16_f32 v16, v16, v17
    v_exp_f32 v19, v19
    v_mfma_f32_32x32x16_bf16 v[80:95], a[60:63], a[140:143], v[80:95]
    s_waitcnt lgkmcnt(4)
    buffer_store_dwordx4 a[232:235], v128, s[56:59], 0 offen offset:2048 sc0 sc1
    v_cvt_pk_bf16_f32 v17, v18, v19
    v_exp_f32 v20, v20
    v_mfma_f32_32x32x16_bf16 v[0:15], v[228:231], v[52:55], v[0:15]
    s_waitcnt lgkmcnt(2)
    v_exp_f32 v21, v21
    v_exp_f32 v22, v22
    v_cvt_pk_bf16_f32 v18, v20, v21
    v_exp_f32 v23, v23
    v_smfmac_f32_16x16x64_bf16 v[112:115], a[240:243], v[48:55], v158
    s_waitcnt lgkmcnt(0)
    v_cvt_pk_bf16_f32 v19, v22, v23
    v_mfma_f32_32x32x16_bf16 v[32:47], v[168:171], v[104:107], 0
    v_exp_f32 v24, v24
    v_exp_f32 v25, v25
    v_exp_f32 v26, v26
    v_mfma_f32_32x32x16_bf16 v[32:47], v[172:175], v[108:111], v[32:47]
    v_cvt_pk_bf16_f32 v20, v24, v25
    v_exp_f32 v27, v27
    v_exp_f32 v28, v28
    v_cvt_pk_bf16_f32 v21, v26, v27
    v_mfma_f32_16x16x32_bf16 v[140:143], v[160:163], a[192:195], 0
    v_exp_f32 v29, v29
    v_mfma_f32_16x16x32_bf16 v[144:147], v[168:171], a[192:195], 0
    v_cvt_pk_bf16_f32 v22, v28, v29
    v_cvt_pk_bf16_f32 v184, v80, v81
    v_mfma_f32_16x16x32_bf16 v[148:151], v[176:179], a[192:195], 0
    v_exp_f32 v30, v30
    v_mfma_f32_16x16x32_bf16 v[152:155], a[176:179], a[192:195], 0
    v_exp_f32 v31, v31
    v_mfma_f32_16x16x32_bf16 v[140:143], v[164:167], a[196:199], v[140:143]
    v_cvt_pk_bf16_f32 v23, v30, v31
    v_cvt_pk_bf16_f32 v185, v82, v83
    v_mfma_f32_16x16x32_bf16 v[144:147], v[172:175], a[196:199], v[144:147]
    v_cvt_pk_bf16_f32 v186, v84, v85
    v_cvt_pk_bf16_f32 v187, v86, v87
    v_smfmac_f32_16x16x64_bf16 v[116:119], a[240:243], v[16:23], v158
    v_cvt_pk_bf16_f32 v188, v88, v89
    v_mfma_f32_16x16x32_bf16 v[148:151], v[180:183], a[196:199], v[148:151]
    buffer_load_dwordx4 v129, s[24:27], s43 offen offset:2048 nt lds
    v_mfma_f32_16x16x32_bf16 v[152:155], a[180:183], a[196:199], v[152:155]
    v_cvt_pk_bf16_f32 v189, v90, v91
    v_cvt_pk_bf16_f32 v190, v92, v93
    v_cvt_pk_bf16_f32 v191, v94, v95
    v_mfma_f32_32x32x16_bf16 v[80:95], a[128:131], a[80:83], 0
    v_add_f32 v112, v112, v113
    v_rcp_f32 v124, v112
    v_exp_f32 v32, v32
    v_max3_u32 v126, v126, v112, v124
    v_exp_f32 v33, v33
    v_exp_f32 v34, v34
    v_pk_fma_f32 v[48:49], v[0:1], v[124:125], v[64:65] op_sel_hi:[1,0,1]
    v_pk_fma_f32 v[50:51], v[2:3], v[124:125], v[66:67] op_sel_hi:[1,0,1]
    v_pk_fma_f32 v[52:53], v[4:5], v[124:125], v[68:69] op_sel_hi:[1,0,1]
    v_pk_fma_f32 v[54:55], v[6:7], v[124:125], v[70:71] op_sel_hi:[1,0,1]
    v_pk_fma_f32 v[56:57], v[8:9], v[124:125], v[72:73] op_sel_hi:[1,0,1]
    v_pk_fma_f32 v[58:59], v[10:11], v[124:125], v[74:75] op_sel_hi:[1,0,1]
    v_pk_fma_f32 v[60:61], v[12:13], v[124:125], v[76:77] op_sel_hi:[1,0,1]
    v_pk_fma_f32 v[62:63], v[14:15], v[124:125], v[78:79] op_sel_hi:[1,0,1]
    v_mfma_f32_32x32x16_bf16 v[80:95], a[132:135], a[84:87], v[80:95]
    v_cvt_pk_bf16_f32 v48, v48, v49
    v_pk_max_i16 v48, v48, 0
    v_cvt_pk_bf16_f32 v49, v50, v51
    v_pk_max_i16 v49, v49, 0
    v_cvt_pk_bf16_f32 v50, v52, v53
    v_pk_max_i16 v50, v50, 0
    v_mfma_f32_32x32x16_bf16 v[80:95], a[136:139], a[88:91], v[80:95]
    v_cvt_pk_bf16_f32 v51, v54, v55
    v_pk_max_i16 v51, v51, 0
    v_cvt_pk_bf16_f32 v52, v56, v57
    v_pk_max_i16 v52, v52, 0
    v_cvt_pk_bf16_f32 v53, v58, v59
    v_pk_max_i16 v53, v53, 0
    v_mfma_f32_32x32x16_bf16 v[80:95], a[140:143], a[92:95], v[80:95]
    ds_write_b128 v130, v[48:51] offset:12288
    v_cvt_pk_bf16_f32 v54, v60, v61
    v_mfma_f32_32x32x16_bf16 v[0:15], v[208:211], v[16:19], 0
    v_pk_max_i16 v54, v54, 0
    v_cvt_pk_bf16_f32 v55, v62, v63
    v_pk_max_i16 v55, v55, 0
    v_cvt_pk_bf16_f32 v32, v32, v33
    v_exp_f32 v35, v35
    v_mfma_f32_32x32x16_bf16 v[0:15], v[212:215], v[20:23], v[0:15]
    ds_write_b128 v130, v[52:55] offset:12544
    v_cvt_pk_bf16_f32 v33, v34, v35
    v_mfma_f32_32x32x16_bf16 v[64:79], a[0:3], a[160:163], 0
    v_exp_f32 v36, v36
    v_exp_f32 v37, v37
    v_exp_f32 v38, v38
    v_mfma_f32_32x32x16_bf16 v[64:79], a[4:7], a[164:167], v[64:79]
    buffer_store_dwordx4 a[236:239], v128, s[56:59], 0 offen offset:3072 sc0 sc1
    v_cvt_pk_bf16_f32 v34, v36, v37
    v_exp_f32 v39, v39
    v_mfma_f32_32x32x16_bf16 v[64:79], a[8:11], a[168:171], v[64:79]
    s_cselect_b32 s58, 4096, 0
    v_cvt_pk_bf16_f32 v35, v38, v39
    v_exp_f32 v40, v40
    v_exp_f32 v41, v41
    v_cvt_pk_bf16_f32 v232, v80, v81
    v_mfma_f32_32x32x16_bf16 v[64:79], a[12:15], a[172:175], v[64:79]
    s_add_u32 s56, s28, s44
    v_cvt_pk_bf16_f32 v36, v40, v41
    v_exp_f32 v42, v42
    v_exp_f32 v43, v43
    v_cvt_pk_bf16_f32 v233, v82, v83
    v_mfma_f32_32x32x16_bf16 v[48:63], v[176:179], v[104:107], 0
    s_addc_u32 s57, s29, 0
    v_cvt_pk_bf16_f32 v37, v42, v43
    v_exp_f32 v44, v44
    v_exp_f32 v45, v45
    v_cvt_pk_bf16_f32 v234, v84, v85
    v_mfma_f32_32x32x16_bf16 v[48:63], v[180:183], v[108:111], v[48:63]
    v_cvt_pk_bf16_f32 v38, v44, v45
    v_exp_f32 v46, v46
    v_exp_f32 v47, v47
    v_cvt_pk_bf16_f32 v96, v64, v65
    v_mfma_f32_32x32x16_bf16 v[0:15], v[216:219], v[32:35], v[0:15]
    v_cvt_pk_bf16_f32 v39, v46, v47
    v_cvt_pk_bf16_f32 v97, v66, v67
    v_cvt_pk_bf16_f32 v98, v68, v69
    v_cvt_pk_bf16_f32 v99, v70, v71
    v_cvt_pk_bf16_f32 v100, v72, v73
    v_cvt_pk_bf16_f32 v101, v74, v75
    v_smfmac_f32_16x16x64_bf16 v[116:119], a[240:243], v[32:39], v158
    v_cvt_pk_bf16_f32 v102, v76, v77
    v_mfma_f32_32x32x16_bf16 v[16:31], v[160:163], v[96:99], 0
    v_cvt_pk_bf16_f32 v103, v78, v79
    v_cvt_pk_bf16_f32 v235, v86, v87
    v_cvt_pk_bf16_f32 v236, v88, v89
    v_cvt_pk_bf16_f32 v237, v90, v91
    v_cvt_pk_bf16_f32 v238, v92, v93
    v_cvt_pk_bf16_f32 v239, v94, v95
    v_mfma_f32_32x32x8_bf16 v[0:15], a[250:251], v[122:123], v[0:15]
    v_exp_f32 v48, v48
    v_exp_f32 v49, v49
    v_exp_f32 v50, v50
    v_mfma_f32_16x16x32_bf16 v[120:123], a[176:179], v[96:99], 0
    buffer_load_dwordx4 v129, s[24:27], s43 offen offset:3072 nt lds
    v_mfma_f32_16x16x32_bf16 v[120:123], a[180:183], v[100:103], v[120:123]
    s_add_u32 m0, s42, 8192
    v_cvt_pk_bf16_f32 v48, v48, v49
    v_exp_f32 v51, v51
    v_mfma_f32_32x32x16_bf16 v[64:79], a[96:99], a[144:147], 0
    s_add_u32 s43, s48, 8192
    v_cvt_pk_bf16_f32 v49, v50, v51
    v_exp_f32 v52, v52
    v_exp_f32 v53, v53
    v_exp_f32 v54, v54
    v_mfma_f32_32x32x16_bf16 v[0:15], v[220:223], v[36:39], v[0:15]
    s_add_u32 s46, s40, 12288
    v_cvt_pk_bf16_f32 v50, v52, v53
    v_exp_f32 v55, v55
    v_exp_f32 v120, v120
    v_cvt_pk_bf16_f32 v51, v54, v55
    v_mfma_f32_32x32x16_bf16 v[64:79], a[100:103], a[148:151], v[64:79]
    v_exp_f32 v121, v121
    v_exp_f32 v56, v56
    v_cvt_pk_bf16_f32 v122, v120, v121
    v_exp_f32 v57, v57
    v_mfma_f32_32x32x16_bf16 v[64:79], a[104:107], a[152:155], v[64:79]
    ds_read_b128 a[224:227], v131 offset:20480
    v_cvt_pk_bf16_f32 v52, v56, v57
    v_exp_f32 v58, v58
    v_exp_f32 v59, v59
    v_mfma_f32_32x32x16_bf16 v[64:79], a[108:111], a[156:159], v[64:79]
    ds_read_b128 a[228:231], v131 offset:21504
    v_cvt_pk_bf16_f32 v53, v58, v59
    v_exp_f32 v60, v60
    v_exp_f32 v61, v61
    v_mfma_f32_16x16x16_bf16 v[112:115], a[248:249], v[122:123], 0
    ds_read_b128 a[232:235], v131 offset:22528
    v_cvt_pk_bf16_f32 v54, v60, v61
    v_mfma_f32_32x32x16_bf16 v[16:31], v[164:167], v[100:103], v[16:31]
    ds_read_b128 a[236:239], v131 offset:23552
    v_exp_f32 v62, v62
    v_exp_f32 v63, v63
    v_mfma_f32_32x32x16_bf16 v[0:15], v[224:227], v[48:51], v[0:15]
    v_cvt_pk_bf16_f32 v55, v62, v63
    ds_read_b128 a[200:203], v133 offset:768
    s_waitcnt lgkmcnt(4)
    buffer_store_dwordx4 a[224:227], v128, s[56:59], 0 offen offset:0 sc0 sc1
    v_mfma_f32_32x32x16_bf16 v[80:95], a[48:51], a[144:147], 0
    ds_read_b128 a[204:207], v133 offset:896
    s_nop 1
    v_exp_f32 v16, v16
    v_mfma_f32_32x32x16_bf16 v[80:95], a[52:55], a[148:151], v[80:95]
    s_waitcnt lgkmcnt(4)
    v_exp_f32 v17, v17
    v_exp_f32 v18, v18
    v_cvt_pk_bf16_f32 v16, v16, v17
    v_exp_f32 v19, v19
    v_mfma_f32_32x32x16_bf16 v[80:95], a[56:59], a[152:155], v[80:95]
    s_waitcnt lgkmcnt(2)
    v_cvt_pk_bf16_f32 v17, v18, v19
    v_exp_f32 v20, v20
    v_exp_f32 v21, v21
    v_exp_f32 v22, v22
    v_mfma_f32_32x32x16_bf16 v[80:95], a[60:63], a[156:159], v[80:95]
    s_waitcnt lgkmcnt(1)
    v_cvt_pk_bf16_f32 v18, v20, v21
    v_exp_f32 v23, v23
    v_exp_f32 v24, v24
    v_cvt_pk_bf16_f32 v19, v22, v23
    v_mfma_f32_32x32x16_bf16 v[0:15], v[228:231], v[52:55], v[0:15]
    s_waitcnt lgkmcnt(0)
    v_exp_f32 v25, v25
    v_exp_f32 v26, v26
    v_cvt_pk_bf16_f32 v20, v24, v25
    v_exp_f32 v27, v27
    v_smfmac_f32_16x16x64_bf16 v[116:119], a[240:243], v[48:55], v158
    v_cvt_pk_bf16_f32 v21, v26, v27
    v_mfma_f32_32x32x16_bf16 v[32:47], v[168:171], v[96:99], 0
    v_exp_f32 v28, v28
    v_exp_f32 v29, v29
    v_exp_f32 v30, v30
    v_mfma_f32_32x32x16_bf16 v[32:47], v[172:175], v[100:103], v[32:47]
    v_cvt_pk_bf16_f32 v22, v28, v29
    v_exp_f32 v31, v31
    v_cvt_pk_bf16_f32 v192, v80, v81
    v_cvt_pk_bf16_f32 v23, v30, v31
    v_cvt_pk_bf16_f32 v193, v82, v83
    v_mfma_f32_16x16x32_bf16 v[140:143], v[184:187], a[200:203], v[140:143]
    buffer_load_dwordx4 v128, s[24:27], s43 offen offset:0 nt lds
    v_smfmac_f32_16x16x64_bf16 v[112:115], a[240:243], v[16:23], v158
    v_cvt_pk_bf16_f32 v194, v84, v85
    v_mfma_f32_16x16x32_bf16 v[152:155], a[184:187], a[200:203], v[152:155]
    v_cvt_pk_bf16_f32 v195, v86, v87
    v_cvt_pk_bf16_f32 v196, v88, v89
    v_mfma_f32_16x16x32_bf16 v[140:143], v[188:191], a[204:207], v[140:143]
    v_cvt_pk_bf16_f32 v197, v90, v91
    v_cvt_pk_bf16_f32 v198, v92, v93
    v_mfma_f32_16x16x32_bf16 v[144:147], v[192:195], a[200:203], v[144:147]
    v_cvt_pk_bf16_f32 v199, v94, v95
    v_add_f32 v116, v116, v117
    v_mfma_f32_32x32x16_bf16 v[80:95], a[144:147], a[80:83], 0
    v_rcp_f32 v125, v116
    v_exp_f32 v32, v32
    v_max3_u32 v126, v126, v116, v125
    v_exp_f32 v33, v33
    v_exp_f32 v34, v34
    v_pk_fma_f32 v[48:49], v[0:1], v[124:125], v[64:65] op_sel:[0,1,0] op_sel_hi:[1,1,1]
    v_pk_fma_f32 v[50:51], v[2:3], v[124:125], v[66:67] op_sel:[0,1,0] op_sel_hi:[1,1,1]
    v_pk_fma_f32 v[52:53], v[4:5], v[124:125], v[68:69] op_sel:[0,1,0] op_sel_hi:[1,1,1]
    v_pk_fma_f32 v[54:55], v[6:7], v[124:125], v[70:71] op_sel:[0,1,0] op_sel_hi:[1,1,1]
    v_pk_fma_f32 v[56:57], v[8:9], v[124:125], v[72:73] op_sel:[0,1,0] op_sel_hi:[1,1,1]
    v_pk_fma_f32 v[58:59], v[10:11], v[124:125], v[74:75] op_sel:[0,1,0] op_sel_hi:[1,1,1]
    v_pk_fma_f32 v[60:61], v[12:13], v[124:125], v[76:77] op_sel:[0,1,0] op_sel_hi:[1,1,1]
    v_pk_fma_f32 v[62:63], v[14:15], v[124:125], v[78:79] op_sel:[0,1,0] op_sel_hi:[1,1,1]
    v_mfma_f32_32x32x16_bf16 v[80:95], a[148:151], a[84:87], v[80:95]
    v_cvt_pk_bf16_f32 v48, v48, v49
    v_pk_max_i16 v48, v48, 0
    v_cvt_pk_bf16_f32 v49, v50, v51
    v_pk_max_i16 v49, v49, 0
    v_cvt_pk_bf16_f32 v50, v52, v53
    v_pk_max_i16 v50, v50, 0
    v_mfma_f32_32x32x16_bf16 v[80:95], a[152:155], a[88:91], v[80:95]
    v_cvt_pk_bf16_f32 v51, v54, v55
    v_pk_max_i16 v51, v51, 0
    v_cvt_pk_bf16_f32 v52, v56, v57
    v_pk_max_i16 v52, v52, 0
    v_cvt_pk_bf16_f32 v53, v58, v59
    v_pk_max_i16 v53, v53, 0
    v_mfma_f32_32x32x16_bf16 v[80:95], a[156:159], a[92:95], v[80:95]
    ds_write_b128 v130, v[48:51] offset:16384
    v_cvt_pk_bf16_f32 v54, v60, v61
    v_mfma_f32_32x32x16_bf16 v[0:15], v[208:211], v[16:19], 0
    v_pk_max_i16 v54, v54, 0
    v_cvt_pk_bf16_f32 v55, v62, v63
    v_pk_max_i16 v55, v55, 0
    v_cvt_pk_bf16_f32 v32, v32, v33
    v_exp_f32 v35, v35
    v_mfma_f32_32x32x16_bf16 v[0:15], v[212:215], v[20:23], v[0:15]
    buffer_store_dwordx4 a[228:231], v128, s[56:59], 0 offen offset:1024 sc0 sc1
    ds_write_b128 v130, v[52:55] offset:16640
    v_mfma_f32_32x32x16_bf16 v[64:79], a[16:19], a[128:131], 0
    v_cvt_pk_bf16_f32 v33, v34, v35
    v_exp_f32 v36, v36
    v_exp_f32 v37, v37
    v_cvt_pk_bf16_f32 v240, v80, v81
    v_mfma_f32_32x32x16_bf16 v[64:79], a[20:23], a[132:135], v[64:79]
    v_cvt_pk_bf16_f32 v34, v36, v37
    v_exp_f32 v38, v38
    v_exp_f32 v39, v39
    v_cvt_pk_bf16_f32 v241, v82, v83
    v_mfma_f32_32x32x16_bf16 v[64:79], a[24:27], a[136:139], v[64:79]
    v_cvt_pk_bf16_f32 v35, v38, v39
    v_exp_f32 v40, v40
    v_exp_f32 v41, v41
    v_cvt_pk_bf16_f32 v242, v84, v85
    v_mfma_f32_32x32x16_bf16 v[64:79], a[28:31], a[140:143], v[64:79]
    v_cvt_pk_bf16_f32 v36, v40, v41
    v_exp_f32 v42, v42
    v_exp_f32 v43, v43
    v_cvt_pk_bf16_f32 v243, v86, v87
    v_mfma_f32_32x32x16_bf16 v[48:63], v[176:179], v[96:99], 0
    v_cvt_pk_bf16_f32 v37, v42, v43
    v_exp_f32 v44, v44
    v_exp_f32 v45, v45
    v_cvt_pk_bf16_f32 v244, v88, v89
    v_mfma_f32_32x32x16_bf16 v[48:63], v[180:183], v[100:103], v[48:63]
    v_cvt_pk_bf16_f32 v38, v44, v45
    v_exp_f32 v46, v46
    v_exp_f32 v47, v47
    v_cvt_pk_bf16_f32 v104, v64, v65
    v_mfma_f32_32x32x16_bf16 v[0:15], v[216:219], v[32:35], v[0:15]
    v_cvt_pk_bf16_f32 v39, v46, v47
    v_cvt_pk_bf16_f32 v105, v66, v67
    v_cvt_pk_bf16_f32 v106, v68, v69
    v_cvt_pk_bf16_f32 v107, v70, v71
    v_cvt_pk_bf16_f32 v108, v72, v73
    v_cvt_pk_bf16_f32 v109, v74, v75
    v_smfmac_f32_16x16x64_bf16 v[112:115], a[240:243], v[32:39], v158
    v_cvt_pk_bf16_f32 v110, v76, v77
    v_mfma_f32_32x32x16_bf16 v[16:31], v[184:187], v[104:107], 0
    buffer_load_dwordx4 v128, s[24:27], s43 offen offset:1024 nt lds
    v_cvt_pk_bf16_f32 v111, v78, v79
    v_cvt_pk_bf16_f32 v245, v90, v91
    v_cvt_pk_bf16_f32 v246, v92, v93
    v_cvt_pk_bf16_f32 v247, v94, v95
    v_mfma_f32_32x32x8_bf16 v[0:15], a[250:251], v[122:123], v[0:15]
    v_exp_f32 v48, v48
    v_exp_f32 v49, v49
    v_exp_f32 v50, v50
    v_mfma_f32_16x16x32_bf16 v[120:123], a[184:187], v[104:107], 0
    v_cvt_pk_bf16_f32 v48, v48, v49
    v_exp_f32 v51, v51
    v_mfma_f32_16x16x32_bf16 v[120:123], a[188:191], v[108:111], v[120:123]
    v_cvt_pk_bf16_f32 v49, v50, v51
    v_exp_f32 v52, v52
    v_mfma_f32_32x32x16_bf16 v[64:79], a[96:99], a[160:163], 0
    v_exp_f32 v53, v53
    v_exp_f32 v54, v54
    v_cvt_pk_bf16_f32 v50, v52, v53
    v_exp_f32 v55, v55
    v_mfma_f32_32x32x16_bf16 v[0:15], v[220:223], v[36:39], v[0:15]
    v_cvt_pk_bf16_f32 v51, v54, v55
    v_exp_f32 v120, v120
    v_exp_f32 v121, v121
    v_exp_f32 v56, v56
    v_mfma_f32_32x32x16_bf16 v[64:79], a[100:103], a[164:167], v[64:79]
    v_cvt_pk_bf16_f32 v122, v120, v121
    v_exp_f32 v57, v57
    v_exp_f32 v58, v58
    v_cvt_pk_bf16_f32 v52, v56, v57
    v_mfma_f32_32x32x16_bf16 v[64:79], a[104:107], a[168:171], v[64:79]
    v_exp_f32 v59, v59
    v_exp_f32 v60, v60
    v_cvt_pk_bf16_f32 v53, v58, v59
    v_exp_f32 v61, v61
    v_mfma_f32_32x32x16_bf16 v[64:79], a[108:111], a[172:175], v[64:79]
    v_cvt_pk_bf16_f32 v54, v60, v61
    v_exp_f32 v62, v62
    v_exp_f32 v63, v63
    v_exp_f32 v140, v140
    v_mfma_f32_16x16x16_bf16 v[116:119], a[248:249], v[122:123], 0
    buffer_store_dwordx4 a[232:235], v128, s[56:59], 0 offen offset:2048 sc0 sc1
    v_mfma_f32_32x32x16_bf16 v[16:31], v[188:191], v[108:111], v[16:31]
    v_cvt_pk_bf16_f32 v55, v62, v63
    v_exp_f32 v141, v141
    v_exp_f32 v142, v142
    v_cvt_pk_bf16_f32 v140, v140, v141
    v_mfma_f32_32x32x16_bf16 v[0:15], v[224:227], v[48:51], v[0:15]
    ds_read_b64 v[156:157], v135 offset:1536
    v_exp_f32 v143, v143
    s_nop 0
    v_cvt_pk_bf16_f32 v141, v142, v143
    v_mfma_f32_32x32x16_bf16 v[80:95], a[48:51], a[160:163], 0
    ds_write_b64 v136, v[140:141] offset:0
    s_nop 0
    v_exp_f32 v16, v16
    v_mfma_f32_32x32x16_bf16 v[80:95], a[52:55], a[164:167], v[80:95]
    v_exp_f32 v17, v17
    v_exp_f32 v18, v18
    v_cvt_pk_bf16_f32 v16, v16, v17
    v_exp_f32 v19, v19
    v_mfma_f32_32x32x16_bf16 v[80:95], a[56:59], a[168:171], v[80:95]
    v_cvt_pk_bf16_f32 v17, v18, v19
    v_exp_f32 v20, v20
    v_exp_f32 v21, v21
    v_exp_f32 v22, v22
    v_mfma_f32_32x32x16_bf16 v[80:95], a[60:63], a[172:175], v[80:95]
    s_waitcnt lgkmcnt(1)
    v_cvt_pk_bf16_f32 v18, v20, v21
    v_exp_f32 v23, v23
    v_exp_f32 v24, v24
    v_cvt_pk_bf16_f32 v19, v22, v23
    v_mfma_f32_32x32x16_bf16 v[0:15], v[228:231], v[52:55], v[0:15]
    v_exp_f32 v25, v25
    v_exp_f32 v26, v26
    v_cvt_pk_bf16_f32 v20, v24, v25
    v_exp_f32 v27, v27
    v_smfmac_f32_16x16x64_bf16 v[112:115], a[240:243], v[48:55], v158
    v_cvt_pk_bf16_f32 v21, v26, v27
    v_mfma_f32_32x32x16_bf16 v[32:47], v[192:195], v[104:107], 0
    buffer_load_dwordx4 v129, s[24:27], s43 offen offset:2048 nt lds
    v_exp_f32 v28, v28
    v_exp_f32 v29, v29
    v_mfma_f32_32x32x16_bf16 v[32:47], v[196:199], v[108:111], v[32:47]
    v_cvt_pk_bf16_f32 v22, v28, v29
    v_exp_f32 v30, v30
    v_exp_f32 v31, v31
    v_cvt_pk_bf16_f32 v200, v80, v81
    v_mfma_f32_16x16x32_bf16 v[144:147], v[196:199], a[204:207], v[144:147]
    v_cvt_pk_bf16_f32 v23, v30, v31
    v_cvt_pk_bf16_f32 v201, v82, v83
    v_mfma_f32_16x16x32_bf16 v[152:155], a[188:191], a[204:207], v[152:155]
    v_cvt_pk_bf16_f32 v202, v84, v85
    v_cvt_pk_bf16_f32 v203, v86, v87
    v_smfmac_f32_16x16x64_bf16 v[116:119], a[240:243], v[16:23], v158
    v_cvt_pk_bf16_f32 v204, v88, v89
    v_mfma_f32_16x16x32_bf16 v[148:151], v[200:203], a[200:203], v[148:151]
    v_cvt_pk_bf16_f32 v205, v90, v91
    v_cvt_pk_bf16_f32 v206, v92, v93
    v_cvt_pk_bf16_f32 v207, v94, v95
    v_mfma_f32_32x32x16_bf16 v[80:95], a[160:163], a[80:83], 0
    v_add_f32 v112, v112, v113
    v_rcp_f32 v124, v112
    v_exp_f32 v32, v32
    v_max3_u32 v126, v126, v112, v124
    v_exp_f32 v33, v33
    v_exp_f32 v34, v34
    v_pk_fma_f32 v[48:49], v[0:1], v[124:125], v[64:65] op_sel_hi:[1,0,1]
    v_pk_fma_f32 v[50:51], v[2:3], v[124:125], v[66:67] op_sel_hi:[1,0,1]
    v_pk_fma_f32 v[52:53], v[4:5], v[124:125], v[68:69] op_sel_hi:[1,0,1]
    v_pk_fma_f32 v[54:55], v[6:7], v[124:125], v[70:71] op_sel_hi:[1,0,1]
    v_pk_fma_f32 v[56:57], v[8:9], v[124:125], v[72:73] op_sel_hi:[1,0,1]
    v_pk_fma_f32 v[58:59], v[10:11], v[124:125], v[74:75] op_sel_hi:[1,0,1]
    v_pk_fma_f32 v[60:61], v[12:13], v[124:125], v[76:77] op_sel_hi:[1,0,1]
    v_pk_fma_f32 v[62:63], v[14:15], v[124:125], v[78:79] op_sel_hi:[1,0,1]
    v_mfma_f32_32x32x16_bf16 v[80:95], a[164:167], a[84:87], v[80:95]
    v_cvt_pk_bf16_f32 v48, v48, v49
    v_pk_max_i16 v48, v48, 0
    v_cvt_pk_bf16_f32 v49, v50, v51
    v_pk_max_i16 v49, v49, 0
    v_cvt_pk_bf16_f32 v50, v52, v53
    v_pk_max_i16 v50, v50, 0
    v_mfma_f32_32x32x16_bf16 v[80:95], a[168:171], a[88:91], v[80:95]
    v_cvt_pk_bf16_f32 v51, v54, v55
    v_pk_max_i16 v51, v51, 0
    v_cvt_pk_bf16_f32 v52, v56, v57
    v_pk_max_i16 v52, v52, 0
    v_cvt_pk_bf16_f32 v53, v58, v59
    v_pk_max_i16 v53, v53, 0
    v_mfma_f32_32x32x16_bf16 v[80:95], a[172:175], a[92:95], v[80:95]
    buffer_store_dwordx4 a[236:239], v128, s[56:59], 0 offen offset:3072 sc0 sc1
    v_cvt_pk_bf16_f32 v54, v60, v61
    v_pk_max_i16 v54, v54, 0
    v_cvt_pk_bf16_f32 v55, v62, v63
    v_mfma_f32_32x32x16_bf16 v[0:15], v[232:235], v[16:19], 0
    ds_write_b128 v130, v[48:51] offset:20480
    v_pk_max_i16 v55, v55, 0
    v_mfma_f32_32x32x16_bf16 v[0:15], v[236:239], v[20:23], v[0:15]
    ds_write_b128 v130, v[52:55] offset:20736
    v_cvt_pk_bf16_f32 v32, v32, v33
    v_mfma_f32_32x32x16_bf16 v[64:79], a[16:19], a[144:147], 0
    v_exp_f32 v35, v35
    v_exp_f32 v36, v36
    v_cvt_pk_bf16_f32 v33, v34, v35
    v_cvt_pk_bf16_f32 v248, v80, v81
    v_mfma_f32_32x32x16_bf16 v[64:79], a[20:23], a[148:151], v[64:79]
    v_exp_f32 v37, v37
    v_exp_f32 v38, v38
    v_cvt_pk_bf16_f32 v34, v36, v37
    v_cvt_pk_bf16_f32 v249, v82, v83
    v_mfma_f32_32x32x16_bf16 v[64:79], a[24:27], a[152:155], v[64:79]
    v_exp_f32 v39, v39
    v_exp_f32 v40, v40
    v_cvt_pk_bf16_f32 v35, v38, v39
    v_cvt_pk_bf16_f32 v250, v84, v85
    v_mfma_f32_32x32x16_bf16 v[64:79], a[28:31], a[156:159], v[64:79]
    v_exp_f32 v41, v41
    v_exp_f32 v42, v42
    v_cvt_pk_bf16_f32 v36, v40, v41
    v_cvt_pk_bf16_f32 v251, v86, v87
    v_mfma_f32_16x16x32_bf16 v[148:151], v[204:207], a[204:207], v[148:151]
    v_exp_f32 v43, v43
    v_mfma_f32_32x32x16_bf16 v[48:63], v[200:203], v[104:107], 0
    v_cvt_pk_bf16_f32 v37, v42, v43
    v_exp_f32 v44, v44
    v_exp_f32 v45, v45
    v_cvt_pk_bf16_f32 v252, v88, v89
    v_mfma_f32_32x32x16_bf16 v[48:63], v[204:207], v[108:111], v[48:63]
    v_cvt_pk_bf16_f32 v38, v44, v45
    v_exp_f32 v46, v46
    v_exp_f32 v47, v47
    v_cvt_pk_bf16_f32 v96, v64, v65
    v_mfma_f32_32x32x16_bf16 v[0:15], v[240:243], v[32:35], v[0:15]
    buffer_load_dwordx4 v129, s[24:27], s43 offen offset:3072 nt lds
    v_cvt_pk_bf16_f32 v39, v46, v47
    v_cvt_pk_bf16_f32 v97, v66, v67
    v_cvt_pk_bf16_f32 v98, v68, v69
    v_cvt_pk_bf16_f32 v99, v70, v71
    v_smfmac_f32_16x16x64_bf16 v[116:119], a[240:243], v[32:39], v158
    s_add_u32 m0, s42, 0
    s_add_u32 s43, s49, 0
    v_cvt_pk_bf16_f32 v100, v72, v73
    v_mfma_f32_32x32x16_bf16 v[16:31], v[184:187], v[96:99], 0
    s_add_u32 s44, s40, 0
    v_cvt_pk_bf16_f32 v101, v74, v75
    v_cvt_pk_bf16_f32 v102, v76, v77
    v_cvt_pk_bf16_f32 v103, v78, v79
    v_cvt_pk_bf16_f32 v253, v90, v91
    v_cvt_pk_bf16_f32 v254, v92, v93
    v_cvt_pk_bf16_f32 v255, v94, v95
    v_mfma_f32_32x32x8_bf16 v[0:15], a[252:253], v[122:123], v[0:15]
    s_cmp_lt_u32 s44, 0x40000000
    v_exp_f32 v48, v48
    v_exp_f32 v49, v49
    v_exp_f32 v50, v50
    v_mfma_f32_16x16x32_bf16 v[120:123], a[184:187], v[96:99], 0
    s_cselect_b32 s58, 4096, 0
    v_cvt_pk_bf16_f32 v48, v48, v49
    v_add_u32 v139, 2048, v139
    v_mfma_f32_16x16x32_bf16 v[120:123], a[188:191], v[100:103], v[120:123]
    s_cselect_b32 s44, s44, 0
    v_exp_f32 v51, v51
    v_mfma_f32_32x32x16_bf16 v[0:15], v[244:247], v[36:39], v[0:15]
    s_add_u32 s56, s28, s44
    v_cvt_pk_bf16_f32 v49, v50, v51
    v_exp_f32 v52, v52
    v_exp_f32 v53, v53
    v_add_u32 v133, 2048, v133
    v_mfma_f32_32x32x16_bf16 v[64:79], a[112:115], a[128:131], 0
    s_addc_u32 s57, s29, 0
    s_waitcnt vmcnt(16)
    ds_read_b128 a[128:131], v127 offset:0
    v_cvt_pk_bf16_f32 v50, v52, v53
    v_exp_f32 v54, v54
    v_exp_f32 v55, v55
    v_mfma_f32_32x32x16_bf16 v[64:79], a[116:119], a[132:135], v[64:79]
    s_mov_b32 s47, s40
    ds_read_b128 a[132:135], v127 offset:256
    v_cvt_pk_bf16_f32 v51, v54, v55
    v_exp_f32 v120, v120
    v_exp_f32 v121, v121
    v_mfma_f32_32x32x16_bf16 v[64:79], a[120:123], a[136:139], v[64:79]
    s_add_u32 s40, s40, 12800
    ds_read_b128 a[136:139], v127 offset:512
    v_cvt_pk_bf16_f32 v122, v120, v121
    v_exp_f32 v144, v144
    v_exp_f32 v145, v145
    v_mfma_f32_32x32x16_bf16 v[64:79], a[124:127], a[140:143], v[64:79]
    s_mov_b32 s48, s49
    ds_read_b128 a[140:143], v127 offset:768
    v_exp_f32 v146, v146
    v_exp_f32 v147, v147
    v_cvt_pk_bf16_f32 v144, v144, v145
    v_mfma_f32_16x16x16_bf16 v[112:115], a[248:249], v[122:123], 0
    s_add_u32 s49, s49, 12800
    v_cvt_pk_bf16_f32 v145, v146, v147
    v_add_u32 v135, 2048, v135
    v_mfma_f32_32x32x16_bf16 v[16:31], v[188:191], v[100:103], v[16:31]
    s_add_u32 s45, s45, 1
    ds_write_b64 v136, v[144:145] offset:512
    v_exp_f32 v148, v148
    v_exp_f32 v149, v149
    v_mfma_f32_32x32x16_bf16 v[0:15], v[248:251], v[48:51], v[0:15]
    s_cmp_ge_u32 s45, 2
    v_exp_f32 v150, v150
    v_exp_f32 v151, v151
    v_cvt_pk_bf16_f32 v148, v148, v149
    v_cvt_pk_bf16_f32 v149, v150, v151
    v_mfma_f32_32x32x16_bf16 v[32:47], v[192:195], v[96:99], 0
    s_cselect_b32 s49, 0x40000000, s49
    ds_write_b64 v136, v[148:149] offset:1024
    v_exp_f32 v152, v152
    v_exp_f32 v153, v153
    v_mfma_f32_32x32x16_bf16 v[32:47], v[196:199], v[100:103], v[32:47]
    s_cmp_lt_u32 s45, 4
    v_cvt_pk_bf16_f32 v152, v152, v153
    v_cndmask_b32 v154, 0, v152, s[52:53]
    v_exp_f32 v56, v56
    v_exp_f32 v57, v57
    v_exp_f32 v58, v58
    v_cvt_pk_bf16_f32 v52, v56, v57
    v_exp_f32 v59, v59
    v_exp_f32 v60, v60
    v_cvt_pk_bf16_f32 v53, v58, v59
    v_exp_f32 v61, v61
    v_exp_f32 v62, v62
    v_cvt_pk_bf16_f32 v54, v60, v61
    v_exp_f32 v63, v63
    v_exp_f32 v16, v16
    v_cvt_pk_bf16_f32 v55, v62, v63
    v_exp_f32 v17, v17
    v_exp_f32 v18, v18
    v_mfma_f32_32x32x16_bf16 v[0:15], v[252:255], v[52:55], v[0:15]
    s_waitcnt lgkmcnt(2)
    ds_write_b64 v136, v[154:155] offset:1536
    v_cvt_pk_bf16_f32 v16, v16, v17
    v_exp_f32 v19, v19
    v_mfma_f32_32x32x16_bf16 v[80:95], a[32:35], a[128:131], 0
    ds_read_b64 a[208:209], v159 offset:1536
    v_cvt_pk_bf16_f32 v17, v18, v19
    v_exp_f32 v20, v20
    v_exp_f32 v21, v21
    v_mfma_f32_32x32x16_bf16 v[80:95], a[36:39], a[132:135], v[80:95]
    ds_read_b128 a[216:219], v137 offset:0
    v_cvt_pk_bf16_f32 v18, v20, v21
    v_exp_f32 v22, v22
    v_exp_f32 v23, v23
    v_mfma_f32_32x32x16_bf16 v[80:95], a[40:43], a[136:139], v[80:95]
    ds_read_b128 a[220:223], v137 offset:256
    v_cvt_pk_bf16_f32 v19, v22, v23
    v_exp_f32 v24, v24
    v_exp_f32 v25, v25
    v_mfma_f32_32x32x16_bf16 v[80:95], a[44:47], a[140:143], v[80:95]
    ds_read_b128 a[192:195], v137 offset:512
    v_cvt_pk_bf16_f32 v20, v24, v25
    v_exp_f32 v26, v26
    v_exp_f32 v27, v27
    v_smfmac_f32_16x16x64_bf16 v[116:119], a[240:243], v[48:55], v158
    ds_read_b128 a[196:199], v137 offset:768
    v_cvt_pk_bf16_f32 v21, v26, v27
    v_exp_f32 v28, v28
    v_exp_f32 v29, v29
    v_exp_f32 v30, v30
    v_cvt_pk_bf16_f32 v22, v28, v29
    v_exp_f32 v31, v31
    v_cvt_pk_bf16_f32 v160, v80, v81
    v_cvt_pk_bf16_f32 v23, v30, v31
    v_cvt_pk_bf16_f32 v161, v82, v83
    v_cvt_pk_bf16_f32 v162, v84, v85
    v_smfmac_f32_16x16x64_bf16 v[112:115], a[240:243], v[16:23], v158
    s_waitcnt lgkmcnt(2)
    ds_read_b128 a[200:203], v137 offset:1024
    v_mfma_f32_16x16x16_bf16 v[148:151], a[254:255], a[208:209], 0
    buffer_load_dwordx4 v128, s[24:27], s43 offen offset:0 nt lds
    v_mfma_f32_16x16x16_bf16 v[140:143], a[250:251], a[208:209], 0
    s_waitcnt lgkmcnt(2)
    ds_read_b128 a[204:207], v137 offset:1280
    v_cvt_pk_bf16_f32 v163, v86, v87
    v_mfma_f32_16x16x16_bf16 v[144:147], a[252:253], a[208:209], 0
    v_cvt_pk_bf16_f32 v164, v88, v89
    v_cvt_pk_bf16_f32 v165, v90, v91
    v_mfma_f32_16x16x32_bf16 v[140:143], v[208:211], a[216:219], v[140:143]
    s_waitcnt lgkmcnt(2)
    v_cvt_pk_bf16_f32 v166, v92, v93
    v_cvt_pk_bf16_f32 v167, v94, v95
    v_mfma_f32_16x16x32_bf16 v[144:147], v[232:235], a[216:219], v[144:147]
    v_add_f32 v116, v116, v117
    v_rcp_f32 v125, v116
    v_exp_f32 v32, v32
    v_pk_fma_f32 v[48:49], v[0:1], v[124:125], v[64:65] op_sel:[0,1,0] op_sel_hi:[1,1,1]
    v_pk_fma_f32 v[50:51], v[2:3], v[124:125], v[66:67] op_sel:[0,1,0] op_sel_hi:[1,1,1]
    v_pk_fma_f32 v[52:53], v[4:5], v[124:125], v[68:69] op_sel:[0,1,0] op_sel_hi:[1,1,1]
    v_pk_fma_f32 v[54:55], v[6:7], v[124:125], v[70:71] op_sel:[0,1,0] op_sel_hi:[1,1,1]
    v_pk_fma_f32 v[56:57], v[8:9], v[124:125], v[72:73] op_sel:[0,1,0] op_sel_hi:[1,1,1]
    v_pk_fma_f32 v[58:59], v[10:11], v[124:125], v[74:75] op_sel:[0,1,0] op_sel_hi:[1,1,1]
    v_pk_fma_f32 v[60:61], v[12:13], v[124:125], v[76:77] op_sel:[0,1,0] op_sel_hi:[1,1,1]
    v_pk_fma_f32 v[62:63], v[14:15], v[124:125], v[78:79] op_sel:[0,1,0] op_sel_hi:[1,1,1]
    v_mfma_f32_16x16x32_bf16 v[140:143], v[212:215], a[220:223], v[140:143]
    s_waitcnt lgkmcnt(1)
    v_cvt_pk_bf16_f32 v48, v48, v49
    v_pk_max_i16 v48, v48, 0
    v_mfma_f32_16x16x32_bf16 v[144:147], v[236:239], a[220:223], v[144:147]
    v_cvt_pk_bf16_f32 v49, v50, v51
    v_pk_max_i16 v49, v49, 0
    v_smfmac_f32_16x16x64_bf16 v[148:151], a[244:247], a[216:223], v158
    s_waitcnt lgkmcnt(0)
    v_cvt_pk_bf16_f32 v50, v52, v53
    v_mfma_f32_16x16x32_bf16 v[140:143], v[216:219], a[192:195], v[140:143]
    v_pk_max_i16 v50, v50, 0
    v_cvt_pk_bf16_f32 v51, v54, v55
    v_mfma_f32_16x16x32_bf16 v[144:147], v[240:243], a[192:195], v[144:147]
    v_pk_max_i16 v51, v51, 0
    v_cvt_pk_bf16_f32 v52, v56, v57
    v_mfma_f32_16x16x32_bf16 v[140:143], v[220:223], a[196:199], v[140:143]
    v_pk_max_i16 v52, v52, 0
    v_cvt_pk_bf16_f32 v53, v58, v59
    v_mfma_f32_16x16x32_bf16 v[144:147], v[244:247], a[196:199], v[144:147]
    v_pk_max_i16 v53, v53, 0
    v_cvt_pk_bf16_f32 v54, v60, v61
    v_smfmac_f32_16x16x64_bf16 v[148:151], a[244:247], a[192:199], v158
    v_pk_max_i16 v54, v54, 0
    v_mfma_f32_16x16x32_bf16 v[140:143], v[224:227], a[200:203], v[140:143]
    v_cvt_pk_bf16_f32 v55, v62, v63
    v_pk_max_i16 v55, v55, 0
    v_mfma_f32_16x16x32_bf16 v[144:147], v[248:251], a[200:203], v[144:147]
    v_exp_f32 v33, v33
    v_mfma_f32_16x16x32_bf16 v[140:143], v[228:231], a[204:207], v[140:143]
    v_cvt_pk_bf16_f32 v32, v32, v33
    v_exp_f32 v34, v34
    v_mfma_f32_16x16x32_bf16 v[144:147], v[252:255], a[204:207], v[144:147]
    buffer_load_dwordx4 v128, s[24:27], s43 offen offset:1024 nt lds
    v_smfmac_f32_16x16x64_bf16 v[148:151], a[244:247], a[200:207], v158
    ds_read_b128 a[176:179], v132 offset:2048
    v_mfma_f32_32x32x16_bf16 v[80:95], a[128:131], a[64:67], 0
    v_exp_f32 v35, v35
    v_exp_f32 v36, v36
    v_cvt_pk_bf16_f32 v33, v34, v35
    v_exp_f32 v37, v37
    v_mfma_f32_32x32x16_bf16 v[80:95], a[132:135], a[68:71], v[80:95]
    s_nop 0
    v_add_f32 v148, v148, v149
    v_rcp_f32 v149, v148
    v_cndmask_b32 v140, v140, v144, s[50:51]
    v_max3_u32 v126, v126, v148, v149
    v_lshlrev_b32 v144, 16, v156
    v_mfma_f32_32x32x16_bf16 v[80:95], a[136:139], a[72:75], v[80:95]
    v_fma_f32 v140, v140, v149, v144
    v_cndmask_b32 v141, v141, v145, s[50:51]
    v_and_b32 v145, 0xffff0000, v156
    v_fma_f32 v141, v141, v149, v145
    v_cndmask_b32 v142, v142, v146, s[50:51]
    v_lshlrev_b32 v146, 16, v157
    v_mfma_f32_32x32x16_bf16 v[80:95], a[140:143], a[76:79], v[80:95]
    v_fma_f32 v142, v142, v149, v146
    v_cndmask_b32 v143, v143, v147, s[50:51]
    v_and_b32 v147, 0xffff0000, v157
    v_fma_f32 v143, v143, v149, v147
    v_cvt_pk_bf16_f32 v140, v140, v141
    v_cvt_pk_bf16_f32 v141, v142, v143
    v_mfma_f32_32x32x16_bf16 v[0:15], v[232:235], v[16:19], 0
    s_waitcnt lgkmcnt(0)
    v_pk_max_i16 v140, v140, 0
    v_pk_max_i16 v141, v141, 0
    v_max3_u32 v126, v126, v116, v125
    v_cvt_pk_bf16_f32 v34, v36, v37
    v_exp_f32 v38, v38
    v_mfma_f32_32x32x16_bf16 v[0:15], v[236:239], v[20:23], v[0:15]
    buffer_store_dwordx2 v[140:141], v138, s[28:31], s46 offen sc0 sc1
    ds_write_b128 v130, v[48:51] offset:12800
    v_mfma_f32_32x32x16_bf16 v[64:79], a[16:19], a[160:163], 0
    v_exp_f32 v39, v39
    v_exp_f32 v40, v40
    v_cvt_pk_bf16_f32 v35, v38, v39
    v_cvt_pk_bf16_f32 v208, v80, v81
    v_mfma_f32_32x32x16_bf16 v[64:79], a[20:23], a[164:167], v[64:79]
    ds_write_b128 v130, v[52:55] offset:13056
    v_cvt_pk_bf16_f32 v209, v82, v83
    v_mfma_f32_32x32x16_bf16 v[64:79], a[24:27], a[168:171], v[64:79]
    ds_read_b128 a[224:227], v131 offset:12288
    v_exp_f32 v41, v41
    v_exp_f32 v42, v42
    v_cvt_pk_bf16_f32 v36, v40, v41
    v_mfma_f32_32x32x16_bf16 v[64:79], a[28:31], a[172:175], v[64:79]
    ds_read_b128 a[228:231], v131 offset:13312
    v_exp_f32 v43, v43
    v_exp_f32 v44, v44
    v_cvt_pk_bf16_f32 v37, v42, v43
    v_mfma_f32_32x32x16_bf16 v[48:63], v[200:203], v[96:99], 0
    ds_read_b128 a[232:235], v131 offset:14336
    v_exp_f32 v45, v45
    v_exp_f32 v46, v46
    v_cvt_pk_bf16_f32 v38, v44, v45
    v_mfma_f32_32x32x16_bf16 v[48:63], v[204:207], v[100:103], v[48:63]
    ds_read_b128 a[236:239], v131 offset:15360
    v_exp_f32 v47, v47
    v_cvt_pk_bf16_f32 v104, v64, v65
    v_cvt_pk_bf16_f32 v39, v46, v47
    v_cvt_pk_bf16_f32 v105, v66, v67
    v_mfma_f32_32x32x16_bf16 v[0:15], v[240:243], v[32:35], v[0:15]
    s_waitcnt lgkmcnt(3)
    buffer_store_dwordx4 a[224:227], v128, s[56:59], 0 offen offset:0 sc0 sc1
    v_cvt_pk_bf16_f32 v106, v68, v69
    v_cvt_pk_bf16_f32 v107, v70, v71
    v_cvt_pk_bf16_f32 v108, v72, v73
    v_smfmac_f32_16x16x64_bf16 v[112:115], a[240:243], v[32:39], v158
    v_cvt_pk_bf16_f32 v109, v74, v75
    v_mfma_f32_32x32x16_bf16 v[16:31], v[184:187], v[104:107], 0
    s_waitcnt lgkmcnt(2)
    v_cvt_pk_bf16_f32 v110, v76, v77
    v_cvt_pk_bf16_f32 v111, v78, v79
    v_cvt_pk_bf16_f32 v210, v84, v85
    v_cvt_pk_bf16_f32 v211, v86, v87
    v_cvt_pk_bf16_f32 v212, v88, v89
    v_cvt_pk_bf16_f32 v213, v90, v91
    v_mfma_f32_32x32x8_bf16 v[0:15], a[252:253], v[122:123], v[0:15]
    s_waitcnt lgkmcnt(1)
    v_cvt_pk_bf16_f32 v214, v92, v93
    v_cvt_pk_bf16_f32 v215, v94, v95
    v_exp_f32 v48, v48
    v_exp_f32 v49, v49
    v_mfma_f32_16x16x32_bf16 v[120:123], a[184:187], v[104:107], 0
    s_waitcnt lgkmcnt(0)
    v_cvt_pk_bf16_f32 v48, v48, v49
    v_exp_f32 v50, v50
    v_mfma_f32_16x16x32_bf16 v[120:123], a[188:191], v[108:111], v[120:123]
    buffer_load_dwordx4 v129, s[24:27], s43 offen offset:2048 nt lds
    v_mfma_f32_32x32x16_bf16 v[0:15], v[244:247], v[36:39], v[0:15]
    v_exp_f32 v51, v51
    v_exp_f32 v52, v52
    v_cvt_pk_bf16_f32 v49, v50, v51
    v_exp_f32 v53, v53
    v_mfma_f32_32x32x16_bf16 v[64:79], a[112:115], a[144:147], 0
    s_waitcnt vmcnt(13)
    ds_read_b128 a[144:147], v127 offset:4096
    v_cvt_pk_bf16_f32 v50, v52, v53
    v_exp_f32 v54, v54
    v_exp_f32 v55, v55
    v_mfma_f32_32x32x16_bf16 v[64:79], a[116:119], a[148:151], v[64:79]
    ds_read_b128 a[148:151], v127 offset:4352
    v_cvt_pk_bf16_f32 v51, v54, v55
    v_exp_f32 v120, v120
    v_exp_f32 v121, v121
    v_mfma_f32_32x32x16_bf16 v[64:79], a[120:123], a[152:155], v[64:79]
    ds_read_b128 a[152:155], v127 offset:4608
    buffer_store_dwordx4 a[228:231], v128, s[56:59], 0 offen offset:1024 sc0 sc1
    v_cvt_pk_bf16_f32 v122, v120, v121
    v_exp_f32 v56, v56
    v_mfma_f32_32x32x16_bf16 v[64:79], a[124:127], a[156:159], v[64:79]
    ds_read_b128 a[156:159], v127 offset:4864
    v_exp_f32 v57, v57
    v_exp_f32 v58, v58
    v_cvt_pk_bf16_f32 v52, v56, v57
    v_mfma_f32_16x16x16_bf16 v[116:119], a[248:249], v[122:123], 0
    s_waitcnt lgkmcnt(3)
    v_exp_f32 v59, v59
    v_mfma_f32_32x32x16_bf16 v[16:31], v[188:191], v[108:111], v[16:31]
    v_cvt_pk_bf16_f32 v53, v58, v59
    v_exp_f32 v60, v60
    v_exp_f32 v61, v61
    v_exp_f32 v62, v62
    v_mfma_f32_32x32x16_bf16 v[0:15], v[248:251], v[48:51], v[0:15]
    s_waitcnt lgkmcnt(2)
    v_cvt_pk_bf16_f32 v54, v60, v61
    v_exp_f32 v63, v63
    s_nop 0
    v_cvt_pk_bf16_f32 v55, v62, v63
    v_mfma_f32_32x32x16_bf16 v[80:95], a[32:35], a[144:147], 0
    s_waitcnt lgkmcnt(1)
    ds_read_b128 a[180:183], v132 offset:2176
    v_exp_f32 v16, v16
    v_exp_f32 v17, v17
    v_add_u32 v132, 2048, v132
    v_mfma_f32_32x32x16_bf16 v[80:95], a[36:39], a[148:151], v[80:95]
    s_waitcnt lgkmcnt(1)
    v_cvt_pk_bf16_f32 v16, v16, v17
    v_exp_f32 v18, v18
    v_exp_f32 v19, v19
    v_exp_f32 v20, v20
    v_mfma_f32_32x32x16_bf16 v[80:95], a[40:43], a[152:155], v[80:95]
    v_cvt_pk_bf16_f32 v17, v18, v19
    v_exp_f32 v21, v21
    v_exp_f32 v22, v22
    v_cvt_pk_bf16_f32 v18, v20, v21
    v_mfma_f32_32x32x16_bf16 v[80:95], a[44:47], a[156:159], v[80:95]
    v_exp_f32 v23, v23
    v_exp_f32 v24, v24
    v_cvt_pk_bf16_f32 v19, v22, v23
    v_exp_f32 v25, v25
    v_mfma_f32_32x32x16_bf16 v[0:15], v[252:255], v[52:55], v[0:15]
    s_waitcnt lgkmcnt(0)
    v_cvt_pk_bf16_f32 v20, v24, v25
    v_exp_f32 v26, v26
    v_exp_f32 v27, v27
    v_exp_f32 v28, v28
    v_smfmac_f32_16x16x64_bf16 v[112:115], a[240:243], v[48:55], v158
    v_cvt_pk_bf16_f32 v21, v26, v27
    v_mfma_f32_32x32x16_bf16 v[32:47], v[192:195], v[104:107], 0
    v_exp_f32 v29, v29
    v_exp_f32 v30, v30
    v_cvt_pk_bf16_f32 v22, v28, v29
    v_cvt_pk_bf16_f32 v168, v80, v81
    v_mfma_f32_32x32x16_bf16 v[32:47], v[196:199], v[108:111], v[32:47]
    buffer_store_dwordx4 a[232:235], v128, s[56:59], 0 offen offset:2048 sc0 sc1
    v_exp_f32 v31, v31
    v_cvt_pk_bf16_f32 v169, v82, v83
    v_cvt_pk_bf16_f32 v23, v30, v31
    v_cvt_pk_bf16_f32 v170, v84, v85
    v_cvt_pk_bf16_f32 v171, v86, v87
    v_smfmac_f32_16x16x64_bf16 v[116:119], a[240:243], v[16:23], v158
    v_cvt_pk_bf16_f32 v172, v88, v89
    v_cvt_pk_bf16_f32 v173, v90, v91
    v_cvt_pk_bf16_f32 v174, v92, v93
    v_cvt_pk_bf16_f32 v175, v94, v95
    v_mfma_f32_32x32x16_bf16 v[80:95], a[144:147], a[64:67], 0
    v_add_f32 v112, v112, v113
    v_rcp_f32 v124, v112
    v_exp_f32 v32, v32
    v_max3_u32 v126, v126, v112, v124
    v_exp_f32 v33, v33
    v_exp_f32 v34, v34
    v_pk_fma_f32 v[48:49], v[0:1], v[124:125], v[64:65] op_sel_hi:[1,0,1]
    v_pk_fma_f32 v[50:51], v[2:3], v[124:125], v[66:67] op_sel_hi:[1,0,1]
    v_pk_fma_f32 v[52:53], v[4:5], v[124:125], v[68:69] op_sel_hi:[1,0,1]
    v_pk_fma_f32 v[54:55], v[6:7], v[124:125], v[70:71] op_sel_hi:[1,0,1]
    v_pk_fma_f32 v[56:57], v[8:9], v[124:125], v[72:73] op_sel_hi:[1,0,1]
    v_pk_fma_f32 v[58:59], v[10:11], v[124:125], v[74:75] op_sel_hi:[1,0,1]
    v_pk_fma_f32 v[60:61], v[12:13], v[124:125], v[76:77] op_sel_hi:[1,0,1]
    v_pk_fma_f32 v[62:63], v[14:15], v[124:125], v[78:79] op_sel_hi:[1,0,1]
    v_mfma_f32_32x32x16_bf16 v[80:95], a[148:151], a[68:71], v[80:95]
    buffer_load_dwordx4 v129, s[24:27], s43 offen offset:3072 nt lds
    v_cvt_pk_bf16_f32 v48, v48, v49
    v_pk_max_i16 v48, v48, 0
    v_cvt_pk_bf16_f32 v49, v50, v51
    v_pk_max_i16 v49, v49, 0
    v_mfma_f32_32x32x16_bf16 v[80:95], a[152:155], a[72:75], v[80:95]
    v_cvt_pk_bf16_f32 v50, v52, v53
    v_pk_max_i16 v50, v50, 0
    v_cvt_pk_bf16_f32 v51, v54, v55
    v_pk_max_i16 v51, v51, 0
    v_cvt_pk_bf16_f32 v52, v56, v57
    v_pk_max_i16 v52, v52, 0
    v_mfma_f32_32x32x16_bf16 v[80:95], a[156:159], a[76:79], v[80:95]
    ds_write_b128 v130, v[48:51] offset:16896
    v_cvt_pk_bf16_f32 v53, v58, v59
    v_mfma_f32_32x32x16_bf16 v[0:15], v[232:235], v[16:19], 0
    v_pk_max_i16 v53, v53, 0
    v_cvt_pk_bf16_f32 v54, v60, v61
    v_pk_max_i16 v54, v54, 0
    v_cvt_pk_bf16_f32 v55, v62, v63
    v_pk_max_i16 v55, v55, 0
    v_cvt_pk_bf16_f32 v32, v32, v33
    v_mfma_f32_32x32x16_bf16 v[0:15], v[236:239], v[20:23], v[0:15]
    ds_read_b32 a250, v134 offset:3072
    v_exp_f32 v35, v35
    v_exp_f32 v36, v36
    v_cvt_pk_bf16_f32 v33, v34, v35
    v_mfma_f32_32x32x16_bf16 v[64:79], a[0:3], a[128:131], 0
    ds_write_b128 v130, v[52:55] offset:17152
    v_cvt_pk_bf16_f32 v216, v80, v81
    v_mfma_f32_32x32x16_bf16 v[64:79], a[4:7], a[132:135], v[64:79]
    v_exp_f32 v37, v37
    v_exp_f32 v38, v38
    v_cvt_pk_bf16_f32 v34, v36, v37
    v_cvt_pk_bf16_f32 v217, v82, v83
    v_mfma_f32_32x32x16_bf16 v[64:79], a[8:11], a[136:139], v[64:79]
    v_exp_f32 v39, v39
    v_exp_f32 v40, v40
    v_cvt_pk_bf16_f32 v35, v38, v39
    v_cvt_pk_bf16_f32 v218, v84, v85
    v_mfma_f32_32x32x16_bf16 v[64:79], a[12:15], a[140:143], v[64:79]
    v_exp_f32 v41, v41
    v_exp_f32 v42, v42
    v_cvt_pk_bf16_f32 v36, v40, v41
    v_cvt_pk_bf16_f32 v219, v86, v87
    v_mfma_f32_32x32x16_bf16 v[48:63], v[200:203], v[104:107], 0
    s_waitcnt lgkmcnt(1)
    v_exp_f32 v43, v43
    v_exp_f32 v44, v44
    v_cvt_pk_bf16_f32 v37, v42, v43
    v_cvt_pk_bf16_f32 v220, v88, v89
    v_mfma_f32_32x32x16_bf16 v[48:63], v[204:207], v[108:111], v[48:63]
    v_exp_f32 v45, v45
    v_exp_f32 v46, v46
    v_cvt_pk_bf16_f32 v38, v44, v45
    v_cvt_pk_bf16_f32 v96, v64, v65
    v_mfma_f32_32x32x16_bf16 v[0:15], v[240:243], v[32:35], v[0:15]
    buffer_store_dwordx4 a[236:239], v128, s[56:59], 0 offen offset:3072 sc0 sc1
    v_exp_f32 v47, v47
    v_cvt_pk_bf16_f32 v97, v66, v67
    v_cvt_pk_bf16_f32 v39, v46, v47
    v_cvt_pk_bf16_f32 v98, v68, v69
    v_cvt_pk_bf16_f32 v99, v70, v71
    v_smfmac_f32_16x16x64_bf16 v[116:119], a[240:243], v[32:39], v158
    v_cvt_pk_bf16_f32 v100, v72, v73
    v_mfma_f32_32x32x16_bf16 v[16:31], v[160:163], v[96:99], 0
    v_cvt_pk_bf16_f32 v101, v74, v75
    v_cvt_pk_bf16_f32 v102, v76, v77
    v_cvt_pk_bf16_f32 v103, v78, v79
    v_cvt_pk_bf16_f32 v221, v90, v91
    v_cvt_pk_bf16_f32 v222, v92, v93
    v_cvt_pk_bf16_f32 v223, v94, v95
    v_mfma_f32_32x32x8_bf16 v[0:15], a[252:253], v[122:123], v[0:15]
    v_exp_f32 v48, v48
    v_exp_f32 v49, v49
    v_exp_f32 v50, v50
    v_mfma_f32_16x16x32_bf16 v[120:123], a[176:179], v[96:99], 0
    v_cvt_pk_bf16_f32 v48, v48, v49
    v_add_u32 v134, 2048, v134
    v_mfma_f32_16x16x32_bf16 v[120:123], a[180:183], v[100:103], v[120:123]
    v_exp_f32 v51, v51
    v_mfma_f32_32x32x16_bf16 v[64:79], a[112:115], a[160:163], 0
    s_waitcnt vmcnt(9)
    ds_read_b128 a[160:163], v127 offset:8192
    v_cvt_pk_bf16_f32 v49, v50, v51
    v_exp_f32 v52, v52
    v_exp_f32 v53, v53
    v_mfma_f32_32x32x16_bf16 v[0:15], v[244:247], v[36:39], v[0:15]
    v_cvt_pk_bf16_f32 v50, v52, v53
    v_exp_f32 v54, v54
    v_exp_f32 v55, v55
    v_exp_f32 v120, v120
    v_mfma_f32_32x32x16_bf16 v[64:79], a[116:119], a[164:167], v[64:79]
    ds_read_b128 a[164:167], v127 offset:8448
    v_cvt_pk_bf16_f32 v51, v54, v55
    v_exp_f32 v121, v121
    v_exp_f32 v56, v56
    v_mfma_f32_32x32x16_bf16 v[64:79], a[120:123], a[168:171], v[64:79]
    ds_read_b128 a[168:171], v127 offset:8704
    v_cvt_pk_bf16_f32 v122, v120, v121
    v_exp_f32 v57, v57
    v_exp_f32 v58, v58
    v_mfma_f32_32x32x16_bf16 v[64:79], a[124:127], a[172:175], v[64:79]
    s_waitcnt lgkmcnt(2)
    ds_read_b128 a[172:175], v127 offset:8960
    v_cvt_pk_bf16_f32 v52, v56, v57
    v_exp_f32 v59, v59
    v_exp_f32 v60, v60
    v_mfma_f32_16x16x16_bf16 v[112:115], a[248:249], v[122:123], 0
    v_cvt_pk_bf16_f32 v53, v58, v59
    v_exp_f32 v61, v61
    v_mfma_f32_32x32x16_bf16 v[16:31], v[164:167], v[100:103], v[16:31]
    v_cvt_pk_bf16_f32 v54, v60, v61
    v_exp_f32 v62, v62
    v_exp_f32 v63, v63
    v_mfma_f32_32x32x16_bf16 v[0:15], v[248:251], v[48:51], v[0:15]
    s_waitcnt lgkmcnt(2)
    v_cvt_pk_bf16_f32 v55, v62, v63
    s_waitcnt lgkmcnt(0)
    s_nop 0
    s_cbranch_scc1 L_loop
    v_mfma_f32_32x32x16_bf16 v[0:15], v[252:255], v[52:55], v[0:15]
    s_add_u32 s44, s47, 4096
    ds_read_b128 a[224:227], v131 offset:16384
    s_cmp_lt_u32 s44, 0x40000000
    s_cselect_b32 s58, 4096, 0
    ds_read_b128 a[228:231], v131 offset:17408
    v_smfmac_f32_16x16x64_bf16 v[116:119], a[240:243], v[48:55], v158
    s_cselect_b32 s44, s44, 0
    s_add_u32 s56, s28, s44
    ds_read_b128 a[232:235], v131 offset:18432
    s_addc_u32 s57, s29, 0
    s_add_u32 s44, s47, 8192
    ds_read_b128 a[236:239], v131 offset:19456
    s_cmp_lt_u32 s44, 0x40000000
    s_nop 0
    v_add_f32 v116, v116, v117
    v_rcp_f32 v125, v116
    s_nop 0
    v_pk_fma_f32 v[48:49], v[0:1], v[124:125], v[64:65] op_sel:[0,1,0] op_sel_hi:[1,1,1]
    v_pk_fma_f32 v[50:51], v[2:3], v[124:125], v[66:67] op_sel:[0,1,0] op_sel_hi:[1,1,1]
    v_pk_fma_f32 v[52:53], v[4:5], v[124:125], v[68:69] op_sel:[0,1,0] op_sel_hi:[1,1,1]
    v_pk_fma_f32 v[54:55], v[6:7], v[124:125], v[70:71] op_sel:[0,1,0] op_sel_hi:[1,1,1]
    v_pk_fma_f32 v[56:57], v[8:9], v[124:125], v[72:73] op_sel:[0,1,0] op_sel_hi:[1,1,1]
    v_pk_fma_f32 v[58:59], v[10:11], v[124:125], v[74:75] op_sel:[0,1,0] op_sel_hi:[1,1,1]
    v_pk_fma_f32 v[60:61], v[12:13], v[124:125], v[76:77] op_sel:[0,1,0] op_sel_hi:[1,1,1]
    v_pk_fma_f32 v[62:63], v[14:15], v[124:125], v[78:79] op_sel:[0,1,0] op_sel_hi:[1,1,1]
    v_max3_u32 v126, v126, v116, v125
    v_cvt_pk_bf16_f32 v48, v48, v49
    v_pk_max_i16 v48, v48, 0
    v_cvt_pk_bf16_f32 v49, v50, v51
    v_pk_max_i16 v49, v49, 0
    v_cvt_pk_bf16_f32 v50, v52, v53
    v_pk_max_i16 v50, v50, 0
    v_cvt_pk_bf16_f32 v51, v54, v55
    v_pk_max_i16 v51, v51, 0
    v_cvt_pk_bf16_f32 v52, v56, v57
    v_pk_max_i16 v52, v52, 0
    v_cvt_pk_bf16_f32 v53, v58, v59
    v_pk_max_i16 v53, v53, 0
    v_cvt_pk_bf16_f32 v54, v60, v61
    v_pk_max_i16 v54, v54, 0
    v_cvt_pk_bf16_f32 v55, v62, v63
    v_pk_max_i16 v55, v55, 0
    s_cselect_b32 s44, s44, 0
    s_waitcnt lgkmcnt(3)
    buffer_store_dwordx4 a[224:227], v128, s[56:59], 0 offen offset:0 sc0 sc1
    ds_write_b128 v130, v[48:51] offset:20992
    s_waitcnt lgkmcnt(3)
    buffer_store_dwordx4 a[228:231], v128, s[56:59], 0 offen offset:1024 sc0 sc1
    ds_write_b128 v130, v[52:55] offset:21248
    s_waitcnt lgkmcnt(3)
    buffer_store_dwordx4 a[232:235], v128, s[56:59], 0 offen offset:2048 sc0 sc1
    ds_read_b128 a[224:227], v131 offset:20480
    s_waitcnt lgkmcnt(3)
    buffer_store_dwordx4 a[236:239], v128, s[56:59], 0 offen offset:3072 sc0 sc1
    ds_read_b128 a[228:231], v131 offset:21504
    s_cselect_b32 s58, 4096, 0
    s_add_u32 s56, s28, s44
    ds_read_b128 a[232:235], v131 offset:22528
    s_addc_u32 s57, s29, 0
    ds_read_b128 a[236:239], v131 offset:23552
    s_waitcnt lgkmcnt(3)
    buffer_store_dwordx4 a[224:227], v128, s[56:59], 0 offen offset:0 sc0 sc1
    s_waitcnt lgkmcnt(2)
    buffer_store_dwordx4 a[228:231], v128, s[56:59], 0 offen offset:1024 sc0 sc1
    s_waitcnt lgkmcnt(1)
    buffer_store_dwordx4 a[232:235], v128, s[56:59], 0 offen offset:2048 sc0 sc1
    s_waitcnt lgkmcnt(0)
    buffer_store_dwordx4 a[236:239], v128, s[56:59], 0 offen offset:3072 sc0 sc1
    v_cmp_lt_u32 vcc, s54, v126
    s_nop 0
    s_cmp_lg_u64 vcc, 0
    s_waitcnt vmcnt(0)
    s_cbranch_scc1 L_slow
L_end:
    s_endpgm
L_slow:
    s_waitcnt vmcnt(0) lgkmcnt(0)
    v_mbcnt_lo_u32_b32 v1, -1, 0
    v_mbcnt_hi_u32_b32 v1, -1, v1
    v_and_b32 v6, 31, v1
    v_lshrrev_b32 v7, 5, v1
    v_lshlrev_b32 v2, 7, v6
    v_lshl_add_u32 v2, v7, 4, v2
    v_mov_b32 v3, 0x40000000
    v_cmp_gt_u32 vcc, 4, v6
    s_nop 1
    v_cndmask_b32 v3, v3, v2, vcc
    v_mov_b32 v5, 0xff800000
    s_mov_b32 s56, 0
    s_mov_b32 s57, -1
    s_lshl_b32 s58, s3, 4
    s_lshl_b32 s59, s20, 2
    s_add_u32 s58, s58, s59
    s_mul_i32 s58, s58, 12800
    s_mov_b32 s59, 0
L_sbatch:
    s_add_u32 s60, s58, 0
    s_add_u32 s61, s58, 4096
    s_add_u32 s62, s58, 8192
    s_add_u32 s63, s58, 12288
    buffer_load_dwordx4 v[16:19], v2, s[24:27], s60 offen offset:0
    buffer_load_dwordx4 v[20:23], v2, s[24:27], s60 offen offset:32
    buffer_load_dwordx4 v[24:27], v2, s[24:27], s60 offen offset:64
    buffer_load_dwordx4 v[28:31], v2, s[24:27], s60 offen offset:96
    buffer_load_dwordx4 v[32:35], v2, s[24:27], s61 offen offset:0
    buffer_load_dwordx4 v[36:39], v2, s[24:27], s61 offen offset:32
    buffer_load_dwordx4 v[40:43], v2, s[24:27], s61 offen offset:64
    buffer_load_dwordx4 v[44:47], v2, s[24:27], s61 offen offset:96
    buffer_load_dwordx4 v[48:51], v2, s[24:27], s62 offen offset:0
    buffer_load_dwordx4 v[52:55], v2, s[24:27], s62 offen offset:32
    buffer_load_dwordx4 v[56:59], v2, s[24:27], s62 offen offset:64
    buffer_load_dwordx4 v[60:63], v2, s[24:27], s62 offen offset:96
    buffer_load_dwordx4 v[64:67], v3, s[24:27], s63 offen offset:0
    buffer_load_dwordx4 v[68:71], v3, s[24:27], s63 offen offset:32
    buffer_load_dwordx4 v[72:75], v3, s[24:27], s63 offen offset:64
    buffer_load_dwordx4 v[76:79], v3, s[24:27], s63 offen offset:96
    s_waitcnt vmcnt(15)
    v_mfma_f32_32x32x16_bf16 v[188:203], a[32:35], v[16:19], 0
    s_waitcnt vmcnt(14)
    v_mfma_f32_32x32x16_bf16 v[188:203], a[36:39], v[20:23], v[188:203]
    s_waitcnt vmcnt(13)
    v_mfma_f32_32x32x16_bf16 v[188:203], a[40:43], v[24:27], v[188:203]
    s_waitcnt vmcnt(12)
    v_mfma_f32_32x32x16_bf16 v[188:203], a[44:47], v[28:31], v[188:203]
    s_waitcnt vmcnt(11)
    v_mfma_f32_32x32x16_bf16 v[204:219], a[32:35], v[32:35], 0
    s_waitcnt vmcnt(10)
    v_mfma_f32_32x32x16_bf16 v[204:219], a[36:39], v[36:39], v[204:219]
    s_waitcnt vmcnt(9)
    v_mfma_f32_32x32x16_bf16 v[204:219], a[40:43], v[40:43], v[204:219]
    s_waitcnt vmcnt(8)
    v_mfma_f32_32x32x16_bf16 v[204:219], a[44:47], v[44:47], v[204:219]
    s_waitcnt vmcnt(7)
    v_mfma_f32_32x32x16_bf16 v[220:235], a[32:35], v[48:51], 0
    s_waitcnt vmcnt(6)
    v_mfma_f32_32x32x16_bf16 v[220:235], a[36:39], v[52:55], v[220:235]
    s_waitcnt vmcnt(5)
    v_mfma_f32_32x32x16_bf16 v[220:235], a[40:43], v[56:59], v[220:235]
    s_waitcnt vmcnt(4)
    v_mfma_f32_32x32x16_bf16 v[220:235], a[44:47], v[60:63], v[220:235]
    s_waitcnt vmcnt(3)
    v_mfma_f32_32x32x16_bf16 v[236:251], a[32:35], v[64:67], 0
    s_waitcnt vmcnt(2)
    v_mfma_f32_32x32x16_bf16 v[236:251], a[36:39], v[68:71], v[236:251]
    s_waitcnt vmcnt(1)
    v_mfma_f32_32x32x16_bf16 v[236:251], a[40:43], v[72:75], v[236:251]
    s_waitcnt vmcnt(0)
    v_mfma_f32_32x32x16_bf16 v[236:251], a[44:47], v[76:79], v[236:251]
    v_cvt_pk_bf16_f32 v80, v188, v189
    v_cvt_pk_bf16_f32 v81, v190, v191
    v_cvt_pk_bf16_f32 v82, v192, v193
    v_cvt_pk_bf16_f32 v83, v194, v195
    v_cvt_pk_bf16_f32 v84, v196, v197
    v_cvt_pk_bf16_f32 v85, v198, v199
    v_cvt_pk_bf16_f32 v86, v200, v201
    v_cvt_pk_bf16_f32 v87, v202, v203
    v_cvt_pk_bf16_f32 v88, v204, v205
    v_cvt_pk_bf16_f32 v89, v206, v207
    v_cvt_pk_bf16_f32 v90, v208, v209
    v_cvt_pk_bf16_f32 v91, v210, v211
    v_cvt_pk_bf16_f32 v92, v212, v213
    v_cvt_pk_bf16_f32 v93, v214, v215
    v_cvt_pk_bf16_f32 v94, v216, v217
    v_cvt_pk_bf16_f32 v95, v218, v219
    v_cvt_pk_bf16_f32 v96, v220, v221
    v_cvt_pk_bf16_f32 v97, v222, v223
    v_cvt_pk_bf16_f32 v98, v224, v225
    v_cvt_pk_bf16_f32 v99, v226, v227
    v_cvt_pk_bf16_f32 v100, v228, v229
    v_cvt_pk_bf16_f32 v101, v230, v231
    v_cvt_pk_bf16_f32 v102, v232, v233
    v_cvt_pk_bf16_f32 v103, v234, v235
    v_cvt_pk_bf16_f32 v104, v236, v237
    v_cvt_pk_bf16_f32 v105, v238, v239
    v_cvt_pk_bf16_f32 v106, v240, v241
    v_cvt_pk_bf16_f32 v107, v242, v243
    v_cvt_pk_bf16_f32 v108, v244, v245
    v_cvt_pk_bf16_f32 v109, v246, v247
    v_cvt_pk_bf16_f32 v110, v248, v249
    v_cvt_pk_bf16_f32 v111, v250, v251
    v_mfma_f32_32x32x16_bf16 v[188:203], v[16:19], a[64:67], 0
    v_mfma_f32_32x32x16_bf16 v[188:203], v[20:23], a[68:71], v[188:203]
    v_mfma_f32_32x32x16_bf16 v[188:203], v[24:27], a[72:75], v[188:203]
    v_mfma_f32_32x32x16_bf16 v[188:203], v[28:31], a[76:79], v[188:203]
    v_mfma_f32_32x32x16_bf16 v[204:219], v[32:35], a[64:67], 0
    v_mfma_f32_32x32x16_bf16 v[204:219], v[36:39], a[68:71], v[204:219]
    v_mfma_f32_32x32x16_bf16 v[204:219], v[40:43], a[72:75], v[204:219]
    v_mfma_f32_32x32x16_bf16 v[204:219], v[44:47], a[76:79], v[204:219]
    v_mfma_f32_32x32x16_bf16 v[220:235], v[48:51], a[64:67], 0
    v_mfma_f32_32x32x16_bf16 v[220:235], v[52:55], a[68:71], v[220:235]
    v_mfma_f32_32x32x16_bf16 v[220:235], v[56:59], a[72:75], v[220:235]
    v_mfma_f32_32x32x16_bf16 v[220:235], v[60:63], a[76:79], v[220:235]
    v_mfma_f32_32x32x16_bf16 v[236:251], v[64:67], a[64:67], 0
    v_mfma_f32_32x32x16_bf16 v[236:251], v[68:71], a[68:71], v[236:251]
    v_mfma_f32_32x32x16_bf16 v[236:251], v[72:75], a[72:75], v[236:251]
    v_mfma_f32_32x32x16_bf16 v[236:251], v[76:79], a[76:79], v[236:251]
    v_cvt_pk_bf16_f32 v112, v188, v189
    v_cvt_pk_bf16_f32 v113, v190, v191
    v_cvt_pk_bf16_f32 v114, v192, v193
    v_cvt_pk_bf16_f32 v115, v194, v195
    v_cvt_pk_bf16_f32 v116, v196, v197
    v_cvt_pk_bf16_f32 v117, v198, v199
    v_cvt_pk_bf16_f32 v118, v200, v201
    v_cvt_pk_bf16_f32 v119, v202, v203
    v_cvt_pk_bf16_f32 v120, v204, v205
    v_cvt_pk_bf16_f32 v121, v206, v207
    v_cvt_pk_bf16_f32 v122, v208, v209
    v_cvt_pk_bf16_f32 v123, v210, v211
    v_cvt_pk_bf16_f32 v124, v212, v213
    v_cvt_pk_bf16_f32 v125, v214, v215
    v_cvt_pk_bf16_f32 v126, v216, v217
    v_cvt_pk_bf16_f32 v127, v218, v219
    v_cvt_pk_bf16_f32 v128, v220, v221
    v_cvt_pk_bf16_f32 v129, v222, v223
    v_cvt_pk_bf16_f32 v130, v224, v225
    v_cvt_pk_bf16_f32 v131, v226, v227
    v_cvt_pk_bf16_f32 v132, v228, v229
    v_cvt_pk_bf16_f32 v133, v230, v231
    v_cvt_pk_bf16_f32 v134, v232, v233
    v_cvt_pk_bf16_f32 v135, v234, v235
    v_cvt_pk_bf16_f32 v136, v236, v237
    v_cvt_pk_bf16_f32 v137, v238, v239
    v_cvt_pk_bf16_f32 v138, v240, v241
    v_cvt_pk_bf16_f32 v139, v242, v243
    v_mfma_f32_32x32x16_bf16 v[172:187], a[0:3], v[16:19], 0
    v_mfma_f32_32x32x16_bf16 v[172:187], a[4:7], v[20:23], v[172:187]
    v_mfma_f32_32x32x16_bf16 v[172:187], a[8:11], v[24:27], v[172:187]
    v_mfma_f32_32x32x16_bf16 v[172:187], a[12:15], v[28:31], v[172:187]
    s_nop 11
    v_cvt_pk_bf16_f32 v172, v172, v173
    v_cvt_pk_bf16_f32 v173, v174, v175
    v_cvt_pk_bf16_f32 v174, v176, v177
    v_cvt_pk_bf16_f32 v175, v178, v179
    v_cvt_pk_bf16_f32 v176, v180, v181
    v_cvt_pk_bf16_f32 v177, v182, v183
    v_cvt_pk_bf16_f32 v178, v184, v185
    v_cvt_pk_bf16_f32 v179, v186, v187
    v_mfma_f32_32x32x16_bf16 v[188:203], v[80:83], v[172:175], 0
    s_nop 0
    v_mfma_f32_32x32x16_bf16 v[188:203], v[84:87], v[176:179], v[188:203]
    v_mfma_f32_32x32x16_bf16 v[204:219], v[88:91], v[172:175], 0
    v_mfma_f32_32x32x16_bf16 v[204:219], v[92:95], v[176:179], v[204:219]
    v_mfma_f32_32x32x16_bf16 v[220:235], v[96:99], v[172:175], 0
    v_mfma_f32_32x32x16_bf16 v[220:235], v[100:103], v[176:179], v[220:235]
    v_mfma_f32_32x32x16_bf16 v[236:251], v[104:107], v[172:175], 0
    v_mfma_f32_32x32x16_bf16 v[236:251], v[108:111], v[176:179], v[236:251]
    s_nop 11
    v_cndmask_b32 v236, v236, v5, s[56:57]
    v_cndmask_b32 v237, v237, v5, s[56:57]
    v_cndmask_b32 v238, v238, v5, s[56:57]
    v_cndmask_b32 v239, v239, v5, s[56:57]
    v_max3_f32 v8, v188, v189, v190
    v_max3_f32 v8, v8, v191, v192
    v_max3_f32 v8, v8, v193, v194
    v_max3_f32 v8, v8, v195, v196
    v_max3_f32 v8, v8, v197, v198
    v_max3_f32 v8, v8, v199, v200
    v_max3_f32 v8, v8, v201, v202
    v_max3_f32 v8, v8, v203, v204
    v_max3_f32 v8, v8, v205, v206
    v_max3_f32 v8, v8, v207, v208
    v_max3_f32 v8, v8, v209, v210
    v_max3_f32 v8, v8, v211, v212
    v_max3_f32 v8, v8, v213, v214
    v_max3_f32 v8, v8, v215, v216
    v_max3_f32 v8, v8, v217, v218
    v_max3_f32 v8, v8, v219, v220
    v_max3_f32 v8, v8, v221, v222
    v_max3_f32 v8, v8, v223, v224
    v_max3_f32 v8, v8, v225, v226
    v_max3_f32 v8, v8, v227, v228
    v_max3_f32 v8, v8, v229, v230
    v_max3_f32 v8, v8, v231, v232
    v_max3_f32 v8, v8, v233, v234
    v_max3_f32 v8, v8, v235, v236
    v_max3_f32 v8, v8, v237, v238
    v_max_f32 v8, v8, v239
    v_mov_b32 v9, v8
    s_nop 1
    v_permlane32_swap_b32 v9, v8
    v_max_f32 v8, v8, v9
    v_pk_add_f32 v[188:189], v[188:189], v[8:9] op_sel_hi:[1,0] neg_lo:[0,1] neg_hi:[0,1]
    v_pk_add_f32 v[190:191], v[190:191], v[8:9] op_sel_hi:[1,0] neg_lo:[0,1] neg_hi:[0,1]
    v_pk_add_f32 v[192:193], v[192:193], v[8:9] op_sel_hi:[1,0] neg_lo:[0,1] neg_hi:[0,1]
    v_pk_add_f32 v[194:195], v[194:195], v[8:9] op_sel_hi:[1,0] neg_lo:[0,1] neg_hi:[0,1]
    v_pk_add_f32 v[196:197], v[196:197], v[8:9] op_sel_hi:[1,0] neg_lo:[0,1] neg_hi:[0,1]
    v_pk_add_f32 v[198:199], v[198:199], v[8:9] op_sel_hi:[1,0] neg_lo:[0,1] neg_hi:[0,1]
    v_pk_add_f32 v[200:201], v[200:201], v[8:9] op_sel_hi:[1,0] neg_lo:[0,1] neg_hi:[0,1]
    v_pk_add_f32 v[202:203], v[202:203], v[8:9] op_sel_hi:[1,0] neg_lo:[0,1] neg_hi:[0,1]
    v_pk_add_f32 v[204:205], v[204:205], v[8:9] op_sel_hi:[1,0] neg_lo:[0,1] neg_hi:[0,1]
    v_pk_add_f32 v[206:207], v[206:207], v[8:9] op_sel_hi:[1,0] neg_lo:[0,1] neg_hi:[0,1]
    v_pk_add_f32 v[208:209], v[208:209], v[8:9] op_sel_hi:[1,0] neg_lo:[0,1] neg_hi:[0,1]
    v_pk_add_f32 v[210:211], v[210:211], v[8:9] op_sel_hi:[1,0] neg_lo:[0,1] neg_hi:[0,1]
    v_pk_add_f32 v[212:213], v[212:213], v[8:9] op_sel_hi:[1,0] neg_lo:[0,1] neg_hi:[0,1]
    v_pk_add_f32 v[214:215], v[214:215], v[8:9] op_sel_hi:[1,0] neg_lo:[0,1] neg_hi:[0,1]
    v_pk_add_f32 v[216:217], v[216:217], v[8:9] op_sel_hi:[1,0] neg_lo:[0,1] neg_hi:[0,1]
    v_pk_add_f32 v[218:219], v[218:219], v[8:9] op_sel_hi:[1,0] neg_lo:[0,1] neg_hi:[0,1]
    v_pk_add_f32 v[220:221], v[220:221], v[8:9] op_sel_hi:[1,0] neg_lo:[0,1] neg_hi:[0,1]
    v_pk_add_f32 v[222:223], v[222:223], v[8:9] op_sel_hi:[1,0] neg_lo:[0,1] neg_hi:[0,1]
    v_pk_add_f32 v[224:225], v[224:225], v[8:9] op_sel_hi:[1,0] neg_lo:[0,1] neg_hi:[0,1]
    v_pk_add_f32 v[226:227], v[226:227], v[8:9] op_sel_hi:[1,0] neg_lo:[0,1] neg_hi:[0,1]
    v_pk_add_f32 v[228:229], v[228:229], v[8:9] op_sel_hi:[1,0] neg_lo:[0,1] neg_hi:[0,1]
    v_pk_add_f32 v[230:231], v[230:231], v[8:9] op_sel_hi:[1,0] neg_lo:[0,1] neg_hi:[0,1]
    v_pk_add_f32 v[232:233], v[232:233], v[8:9] op_sel_hi:[1,0] neg_lo:[0,1] neg_hi:[0,1]
    v_pk_add_f32 v[234:235], v[234:235], v[8:9] op_sel_hi:[1,0] neg_lo:[0,1] neg_hi:[0,1]
    v_pk_add_f32 v[236:237], v[236:237], v[8:9] op_sel_hi:[1,0] neg_lo:[0,1] neg_hi:[0,1]
    v_pk_add_f32 v[238:239], v[238:239], v[8:9] op_sel_hi:[1,0] neg_lo:[0,1] neg_hi:[0,1]
    v_exp_f32 v188, v188
    v_exp_f32 v189, v189
    v_exp_f32 v190, v190
    v_exp_f32 v191, v191
    v_exp_f32 v192, v192
    v_exp_f32 v193, v193
    v_exp_f32 v194, v194
    v_exp_f32 v195, v195
    v_exp_f32 v196, v196
    v_exp_f32 v197, v197
    v_exp_f32 v198, v198
    v_exp_f32 v199, v199
    v_exp_f32 v200, v200
    v_exp_f32 v201, v201
    v_exp_f32 v202, v202
    v_exp_f32 v203, v203
    v_exp_f32 v204, v204
    v_exp_f32 v205, v205
    v_exp_f32 v206, v206
    v_exp_f32 v207, v207
    v_exp_f32 v208, v208
    v_exp_f32 v209, v209
    v_exp_f32 v210, v210
    v_exp_f32 v211, v211
    v_exp_f32 v212, v212
    v_exp_f32 v213, v213
    v_exp_f32 v214, v214
    v_exp_f32 v215, v215
    v_exp_f32 v216, v216
    v_exp_f32 v217, v217
    v_exp_f32 v218, v218
    v_exp_f32 v219, v219
    v_exp_f32 v220, v220
    v_exp_f32 v221, v221
    v_exp_f32 v222, v222
    v_exp_f32 v223, v223
    v_exp_f32 v224, v224
    v_exp_f32 v225, v225
    v_exp_f32 v226, v226
    v_exp_f32 v227, v227
    v_exp_f32 v228, v228
    v_exp_f32 v229, v229
    v_exp_f32 v230, v230
    v_exp_f32 v231, v231
    v_exp_f32 v232, v232
    v_exp_f32 v233, v233
    v_exp_f32 v234, v234
    v_exp_f32 v235, v235
    v_exp_f32 v236, v236
    v_exp_f32 v237, v237
    v_exp_f32 v238, v238
    v_exp_f32 v239, v239
    v_pk_add_f32 v[10:11], v[188:189], v[190:191]
    v_pk_add_f32 v[10:11], v[10:11], v[192:193]
    v_pk_add_f32 v[10:11], v[10:11], v[194:195]
    v_pk_add_f32 v[10:11], v[10:11], v[196:197]
    v_pk_add_f32 v[10:11], v[10:11], v[198:199]
    v_pk_add_f32 v[10:11], v[10:11], v[200:201]
    v_pk_add_f32 v[10:11], v[10:11], v[202:203]
    v_pk_add_f32 v[10:11], v[10:11], v[204:205]
    v_pk_add_f32 v[10:11], v[10:11], v[206:207]
    v_pk_add_f32 v[10:11], v[10:11], v[208:209]
    v_pk_add_f32 v[10:11], v[10:11], v[210:211]
    v_pk_add_f32 v[10:11], v[10:11], v[212:213]
    v_pk_add_f32 v[10:11], v[10:11], v[214:215]
    v_pk_add_f32 v[10:11], v[10:11], v[216:217]
    v_pk_add_f32 v[10:11], v[10:11], v[218:219]
    v_pk_add_f32 v[10:11], v[10:11], v[220:221]
    v_pk_add_f32 v[10:11], v[10:11], v[222:223]
    v_pk_add_f32 v[10:11], v[10:11], v[224:225]
    v_pk_add_f32 v[10:11], v[10:11], v[226:227]
    v_pk_add_f32 v[10:11], v[10:11], v[228:229]
    v_pk_add_f32 v[10:11], v[10:11], v[230:231]
    v_pk_add_f32 v[10:11], v[10:11], v[232:233]
    v_pk_add_f32 v[10:11], v[10:11], v[234:235]
    v_pk_add_f32 v[10:11], v[10:11], v[236:237]
    v_pk_add_f32 v[10:11], v[10:11], v[238:239]
    v_add_f32 v10, v10, v11
    v_mov_b32 v11, v10
    s_nop 1
    v_permlane32_swap_b32 v11, v10
    v_add_f32 v10, v10, v11
    v_rcp_f32 v10, v10
    v_cvt_pk_bf16_f32 v188, v188, v189
    v_cvt_pk_bf16_f32 v189, v190, v191
    v_cvt_pk_bf16_f32 v190, v192, v193
    v_cvt_pk_bf16_f32 v191, v194, v195
    v_cvt_pk_bf16_f32 v192, v196, v197
    v_cvt_pk_bf16_f32 v193, v198, v199
    v_cvt_pk_bf16_f32 v194, v200, v201
    v_cvt_pk_bf16_f32 v195, v202, v203
    v_cvt_pk_bf16_f32 v196, v204, v205
    v_cvt_pk_bf16_f32 v197, v206, v207
    v_cvt_pk_bf16_f32 v198, v208, v209
    v_cvt_pk_bf16_f32 v199, v210, v211
    v_cvt_pk_bf16_f32 v200, v212, v213
    v_cvt_pk_bf16_f32 v201, v214, v215
    v_cvt_pk_bf16_f32 v202, v216, v217
    v_cvt_pk_bf16_f32 v203, v218, v219
    v_cvt_pk_bf16_f32 v220, v220, v221
    v_cvt_pk_bf16_f32 v221, v222, v223
    v_cvt_pk_bf16_f32 v222, v224, v225
    v_cvt_pk_bf16_f32 v223, v226, v227
    v_cvt_pk_bf16_f32 v224, v228, v229
    v_cvt_pk_bf16_f32 v225, v230, v231
    v_cvt_pk_bf16_f32 v226, v232, v233
    v_cvt_pk_bf16_f32 v227, v234, v235
    v_cvt_pk_bf16_f32 v228, v236, v237
    v_cvt_pk_bf16_f32 v229, v238, v239
    v_mov_b32 v230, 0
    v_mov_b32 v231, 0
    v_mfma_f32_32x32x16_bf16 v[204:219], a[96:99], v[16:19], 0
    v_mfma_f32_32x32x16_bf16 v[204:219], a[100:103], v[20:23], v[204:219]
    v_mfma_f32_32x32x16_bf16 v[204:219], a[104:107], v[24:27], v[204:219]
    v_mfma_f32_32x32x16_bf16 v[204:219], a[108:111], v[28:31], v[204:219]
    v_mfma_f32_32x32x16_bf16 v[172:187], v[112:115], v[188:191], 0
    v_mfma_f32_32x32x16_bf16 v[172:187], v[116:119], v[192:195], v[172:187]
    v_mfma_f32_32x32x16_bf16 v[172:187], v[120:123], v[196:199], v[172:187]
    v_mfma_f32_32x32x16_bf16 v[172:187], v[124:127], v[200:203], v[172:187]
    v_mfma_f32_32x32x16_bf16 v[172:187], v[128:131], v[220:223], v[172:187]
    v_mfma_f32_32x32x16_bf16 v[172:187], v[132:135], v[224:227], v[172:187]
    v_mfma_f32_32x32x16_bf16 v[172:187], v[136:139], v[228:231], v[172:187]
    s_nop 11
    v_pk_fma_f32 v[172:173], v[172:173], v[10:11], v[204:205] op_sel_hi:[1,0,1]
    v_pk_fma_f32 v[174:175], v[174:175], v[10:11], v[206:207] op_sel_hi:[1,0,1]
    v_pk_fma_f32 v[176:177], v[176:177], v[10:11], v[208:209] op_sel_hi:[1,0,1]
    v_pk_fma_f32 v[178:179], v[178:179], v[10:11], v[210:211] op_sel_hi:[1,0,1]
    v_pk_fma_f32 v[180:181], v[180:181], v[10:11], v[212:213] op_sel_hi:[1,0,1]
    v_pk_fma_f32 v[182:183], v[182:183], v[10:11], v[214:215] op_sel_hi:[1,0,1]
    v_pk_fma_f32 v[184:185], v[184:185], v[10:11], v[216:217] op_sel_hi:[1,0,1]
    v_pk_fma_f32 v[186:187], v[186:187], v[10:11], v[218:219] op_sel_hi:[1,0,1]
    v_cvt_pk_bf16_f32 v172, v172, v173
    v_cvt_pk_bf16_f32 v173, v174, v175
    v_cvt_pk_bf16_f32 v174, v176, v177
    v_cvt_pk_bf16_f32 v175, v178, v179
    v_cvt_pk_bf16_f32 v176, v180, v181
    v_cvt_pk_bf16_f32 v177, v182, v183
    v_cvt_pk_bf16_f32 v178, v184, v185
    v_cvt_pk_bf16_f32 v179, v186, v187
    v_pk_max_i16 v172, v172, 0
    v_pk_max_i16 v173, v173, 0
    v_pk_max_i16 v174, v174, 0
    v_pk_max_i16 v175, v175, 0
    v_pk_max_i16 v176, v176, 0
    v_pk_max_i16 v177, v177, 0
    v_pk_max_i16 v178, v178, 0
    v_pk_max_i16 v179, v179, 0
    buffer_store_dwordx4 v[172:175], v2, s[28:31], s60 offen offset:0
    buffer_store_dwordx4 v[176:179], v2, s[28:31], s60 offen offset:32
    s_nop 1
    v_mfma_f32_32x32x16_bf16 v[172:187], a[0:3], v[32:35], 0
    v_mfma_f32_32x32x16_bf16 v[172:187], a[4:7], v[36:39], v[172:187]
    v_mfma_f32_32x32x16_bf16 v[172:187], a[8:11], v[40:43], v[172:187]
    v_mfma_f32_32x32x16_bf16 v[172:187], a[12:15], v[44:47], v[172:187]
    s_nop 11
    v_cvt_pk_bf16_f32 v172, v172, v173
    v_cvt_pk_bf16_f32 v173, v174, v175
    v_cvt_pk_bf16_f32 v174, v176, v177
    v_cvt_pk_bf16_f32 v175, v178, v179
    v_cvt_pk_bf16_f32 v176, v180, v181
    v_cvt_pk_bf16_f32 v177, v182, v183
    v_cvt_pk_bf16_f32 v178, v184, v185
    v_cvt_pk_bf16_f32 v179, v186, v187
    v_mfma_f32_32x32x16_bf16 v[188:203], v[80:83], v[172:175], 0
    s_nop 0
    v_mfma_f32_32x32x16_bf16 v[188:203], v[84:87], v[176:179], v[188:203]
    v_mfma_f32_32x32x16_bf16 v[204:219], v[88:91], v[172:175], 0
    v_mfma_f32_32x32x16_bf16 v[204:219], v[92:95], v[176:179], v[204:219]
    v_mfma_f32_32x32x16_bf16 v[220:235], v[96:99], v[172:175], 0
    v_mfma_f32_32x32x16_bf16 v[220:235], v[100:103], v[176:179], v[220:235]
    v_mfma_f32_32x32x16_bf16 v[236:251], v[104:107], v[172:175], 0
    v_mfma_f32_32x32x16_bf16 v[236:251], v[108:111], v[176:179], v[236:251]
    s_nop 11
    v_cndmask_b32 v236, v236, v5, s[56:57]
    v_cndmask_b32 v237, v237, v5, s[56:57]
    v_cndmask_b32 v238, v238, v5, s[56:57]
    v_cndmask_b32 v239, v239, v5, s[56:57]
    v_max3_f32 v8, v188, v189, v190
    v_max3_f32 v8, v8, v191, v192
    v_max3_f32 v8, v8, v193, v194
    v_max3_f32 v8, v8, v195, v196
    v_max3_f32 v8, v8, v197, v198
    v_max3_f32 v8, v8, v199, v200
    v_max3_f32 v8, v8, v201, v202
    v_max3_f32 v8, v8, v203, v204
    v_max3_f32 v8, v8, v205, v206
    v_max3_f32 v8, v8, v207, v208
    v_max3_f32 v8, v8, v209, v210
    v_max3_f32 v8, v8, v211, v212
    v_max3_f32 v8, v8, v213, v214
    v_max3_f32 v8, v8, v215, v216
    v_max3_f32 v8, v8, v217, v218
    v_max3_f32 v8, v8, v219, v220
    v_max3_f32 v8, v8, v221, v222
    v_max3_f32 v8, v8, v223, v224
    v_max3_f32 v8, v8, v225, v226
    v_max3_f32 v8, v8, v227, v228
    v_max3_f32 v8, v8, v229, v230
    v_max3_f32 v8, v8, v231, v232
    v_max3_f32 v8, v8, v233, v234
    v_max3_f32 v8, v8, v235, v236
    v_max3_f32 v8, v8, v237, v238
    v_max_f32 v8, v8, v239
    v_mov_b32 v9, v8
    s_nop 1
    v_permlane32_swap_b32 v9, v8
    v_max_f32 v8, v8, v9
    v_pk_add_f32 v[188:189], v[188:189], v[8:9] op_sel_hi:[1,0] neg_lo:[0,1] neg_hi:[0,1]
    v_pk_add_f32 v[190:191], v[190:191], v[8:9] op_sel_hi:[1,0] neg_lo:[0,1] neg_hi:[0,1]
    v_pk_add_f32 v[192:193], v[192:193], v[8:9] op_sel_hi:[1,0] neg_lo:[0,1] neg_hi:[0,1]
    v_pk_add_f32 v[194:195], v[194:195], v[8:9] op_sel_hi:[1,0] neg_lo:[0,1] neg_hi:[0,1]
    v_pk_add_f32 v[196:197], v[196:197], v[8:9] op_sel_hi:[1,0] neg_lo:[0,1] neg_hi:[0,1]
    v_pk_add_f32 v[198:199], v[198:199], v[8:9] op_sel_hi:[1,0] neg_lo:[0,1] neg_hi:[0,1]
    v_pk_add_f32 v[200:201], v[200:201], v[8:9] op_sel_hi:[1,0] neg_lo:[0,1] neg_hi:[0,1]
    v_pk_add_f32 v[202:203], v[202:203], v[8:9] op_sel_hi:[1,0] neg_lo:[0,1] neg_hi:[0,1]
    v_pk_add_f32 v[204:205], v[204:205], v[8:9] op_sel_hi:[1,0] neg_lo:[0,1] neg_hi:[0,1]
    v_pk_add_f32 v[206:207], v[206:207], v[8:9] op_sel_hi:[1,0] neg_lo:[0,1] neg_hi:[0,1]
    v_pk_add_f32 v[208:209], v[208:209], v[8:9] op_sel_hi:[1,0] neg_lo:[0,1] neg_hi:[0,1]
    v_pk_add_f32 v[210:211], v[210:211], v[8:9] op_sel_hi:[1,0] neg_lo:[0,1] neg_hi:[0,1]
    v_pk_add_f32 v[212:213], v[212:213], v[8:9] op_sel_hi:[1,0] neg_lo:[0,1] neg_hi:[0,1]
    v_pk_add_f32 v[214:215], v[214:215], v[8:9] op_sel_hi:[1,0] neg_lo:[0,1] neg_hi:[0,1]
    v_pk_add_f32 v[216:217], v[216:217], v[8:9] op_sel_hi:[1,0] neg_lo:[0,1] neg_hi:[0,1]
    v_pk_add_f32 v[218:219], v[218:219], v[8:9] op_sel_hi:[1,0] neg_lo:[0,1] neg_hi:[0,1]
    v_pk_add_f32 v[220:221], v[220:221], v[8:9] op_sel_hi:[1,0] neg_lo:[0,1] neg_hi:[0,1]
    v_pk_add_f32 v[222:223], v[222:223], v[8:9] op_sel_hi:[1,0] neg_lo:[0,1] neg_hi:[0,1]
    v_pk_add_f32 v[224:225], v[224:225], v[8:9] op_sel_hi:[1,0] neg_lo:[0,1] neg_hi:[0,1]
    v_pk_add_f32 v[226:227], v[226:227], v[8:9] op_sel_hi:[1,0] neg_lo:[0,1] neg_hi:[0,1]
    v_pk_add_f32 v[228:229], v[228:229], v[8:9] op_sel_hi:[1,0] neg_lo:[0,1] neg_hi:[0,1]
    v_pk_add_f32 v[230:231], v[230:231], v[8:9] op_sel_hi:[1,0] neg_lo:[0,1] neg_hi:[0,1]
    v_pk_add_f32 v[232:233], v[232:233], v[8:9] op_sel_hi:[1,0] neg_lo:[0,1] neg_hi:[0,1]
    v_pk_add_f32 v[234:235], v[234:235], v[8:9] op_sel_hi:[1,0] neg_lo:[0,1] neg_hi:[0,1]
    v_pk_add_f32 v[236:237], v[236:237], v[8:9] op_sel_hi:[1,0] neg_lo:[0,1] neg_hi:[0,1]
    v_pk_add_f32 v[238:239], v[238:239], v[8:9] op_sel_hi:[1,0] neg_lo:[0,1] neg_hi:[0,1]
    v_exp_f32 v188, v188
    v_exp_f32 v189, v189
    v_exp_f32 v190, v190
    v_exp_f32 v191, v191
    v_exp_f32 v192, v192
    v_exp_f32 v193, v193
    v_exp_f32 v194, v194
    v_exp_f32 v195, v195
    v_exp_f32 v196, v196
    v_exp_f32 v197, v197
    v_exp_f32 v198, v198
    v_exp_f32 v199, v199
    v_exp_f32 v200, v200
    v_exp_f32 v201, v201
    v_exp_f32 v202, v202
    v_exp_f32 v203, v203
    v_exp_f32 v204, v204
    v_exp_f32 v205, v205
    v_exp_f32 v206, v206
    v_exp_f32 v207, v207
    v_exp_f32 v208, v208
    v_exp_f32 v209, v209
    v_exp_f32 v210, v210
    v_exp_f32 v211, v211
    v_exp_f32 v212, v212
    v_exp_f32 v213, v213
    v_exp_f32 v214, v214
    v_exp_f32 v215, v215
    v_exp_f32 v216, v216
    v_exp_f32 v217, v217
    v_exp_f32 v218, v218
    v_exp_f32 v219, v219
    v_exp_f32 v220, v220
    v_exp_f32 v221, v221
    v_exp_f32 v222, v222
    v_exp_f32 v223, v223
    v_exp_f32 v224, v224
    v_exp_f32 v225, v225
    v_exp_f32 v226, v226
    v_exp_f32 v227, v227
    v_exp_f32 v228, v228
    v_exp_f32 v229, v229
    v_exp_f32 v230, v230
    v_exp_f32 v231, v231
    v_exp_f32 v232, v232
    v_exp_f32 v233, v233
    v_exp_f32 v234, v234
    v_exp_f32 v235, v235
    v_exp_f32 v236, v236
    v_exp_f32 v237, v237
    v_exp_f32 v238, v238
    v_exp_f32 v239, v239
    v_pk_add_f32 v[10:11], v[188:189], v[190:191]
    v_pk_add_f32 v[10:11], v[10:11], v[192:193]
    v_pk_add_f32 v[10:11], v[10:11], v[194:195]
    v_pk_add_f32 v[10:11], v[10:11], v[196:197]
    v_pk_add_f32 v[10:11], v[10:11], v[198:199]
    v_pk_add_f32 v[10:11], v[10:11], v[200:201]
    v_pk_add_f32 v[10:11], v[10:11], v[202:203]
    v_pk_add_f32 v[10:11], v[10:11], v[204:205]
    v_pk_add_f32 v[10:11], v[10:11], v[206:207]
    v_pk_add_f32 v[10:11], v[10:11], v[208:209]
    v_pk_add_f32 v[10:11], v[10:11], v[210:211]
    v_pk_add_f32 v[10:11], v[10:11], v[212:213]
    v_pk_add_f32 v[10:11], v[10:11], v[214:215]
    v_pk_add_f32 v[10:11], v[10:11], v[216:217]
    v_pk_add_f32 v[10:11], v[10:11], v[218:219]
    v_pk_add_f32 v[10:11], v[10:11], v[220:221]
    v_pk_add_f32 v[10:11], v[10:11], v[222:223]
    v_pk_add_f32 v[10:11], v[10:11], v[224:225]
    v_pk_add_f32 v[10:11], v[10:11], v[226:227]
    v_pk_add_f32 v[10:11], v[10:11], v[228:229]
    v_pk_add_f32 v[10:11], v[10:11], v[230:231]
    v_pk_add_f32 v[10:11], v[10:11], v[232:233]
    v_pk_add_f32 v[10:11], v[10:11], v[234:235]
    v_pk_add_f32 v[10:11], v[10:11], v[236:237]
    v_pk_add_f32 v[10:11], v[10:11], v[238:239]
    v_add_f32 v10, v10, v11
    v_mov_b32 v11, v10
    s_nop 1
    v_permlane32_swap_b32 v11, v10
    v_add_f32 v10, v10, v11
    v_rcp_f32 v10, v10
    v_cvt_pk_bf16_f32 v188, v188, v189
    v_cvt_pk_bf16_f32 v189, v190, v191
    v_cvt_pk_bf16_f32 v190, v192, v193
    v_cvt_pk_bf16_f32 v191, v194, v195
    v_cvt_pk_bf16_f32 v192, v196, v197
    v_cvt_pk_bf16_f32 v193, v198, v199
    v_cvt_pk_bf16_f32 v194, v200, v201
    v_cvt_pk_bf16_f32 v195, v202, v203
    v_cvt_pk_bf16_f32 v196, v204, v205
    v_cvt_pk_bf16_f32 v197, v206, v207
    v_cvt_pk_bf16_f32 v198, v208, v209
    v_cvt_pk_bf16_f32 v199, v210, v211
    v_cvt_pk_bf16_f32 v200, v212, v213
    v_cvt_pk_bf16_f32 v201, v214, v215
    v_cvt_pk_bf16_f32 v202, v216, v217
    v_cvt_pk_bf16_f32 v203, v218, v219
    v_cvt_pk_bf16_f32 v220, v220, v221
    v_cvt_pk_bf16_f32 v221, v222, v223
    v_cvt_pk_bf16_f32 v222, v224, v225
    v_cvt_pk_bf16_f32 v223, v226, v227
    v_cvt_pk_bf16_f32 v224, v228, v229
    v_cvt_pk_bf16_f32 v225, v230, v231
    v_cvt_pk_bf16_f32 v226, v232, v233
    v_cvt_pk_bf16_f32 v227, v234, v235
    v_cvt_pk_bf16_f32 v228, v236, v237
    v_cvt_pk_bf16_f32 v229, v238, v239
    v_mov_b32 v230, 0
    v_mov_b32 v231, 0
    v_mfma_f32_32x32x16_bf16 v[204:219], a[96:99], v[32:35], 0
    v_mfma_f32_32x32x16_bf16 v[204:219], a[100:103], v[36:39], v[204:219]
    v_mfma_f32_32x32x16_bf16 v[204:219], a[104:107], v[40:43], v[204:219]
    v_mfma_f32_32x32x16_bf16 v[204:219], a[108:111], v[44:47], v[204:219]
    v_mfma_f32_32x32x16_bf16 v[172:187], v[112:115], v[188:191], 0
    v_mfma_f32_32x32x16_bf16 v[172:187], v[116:119], v[192:195], v[172:187]
    v_mfma_f32_32x32x16_bf16 v[172:187], v[120:123], v[196:199], v[172:187]
    v_mfma_f32_32x32x16_bf16 v[172:187], v[124:127], v[200:203], v[172:187]
    v_mfma_f32_32x32x16_bf16 v[172:187], v[128:131], v[220:223], v[172:187]
    v_mfma_f32_32x32x16_bf16 v[172:187], v[132:135], v[224:227], v[172:187]
    v_mfma_f32_32x32x16_bf16 v[172:187], v[136:139], v[228:231], v[172:187]
    s_nop 11
    v_pk_fma_f32 v[172:173], v[172:173], v[10:11], v[204:205] op_sel_hi:[1,0,1]
    v_pk_fma_f32 v[174:175], v[174:175], v[10:11], v[206:207] op_sel_hi:[1,0,1]
    v_pk_fma_f32 v[176:177], v[176:177], v[10:11], v[208:209] op_sel_hi:[1,0,1]
    v_pk_fma_f32 v[178:179], v[178:179], v[10:11], v[210:211] op_sel_hi:[1,0,1]
    v_pk_fma_f32 v[180:181], v[180:181], v[10:11], v[212:213] op_sel_hi:[1,0,1]
    v_pk_fma_f32 v[182:183], v[182:183], v[10:11], v[214:215] op_sel_hi:[1,0,1]
    v_pk_fma_f32 v[184:185], v[184:185], v[10:11], v[216:217] op_sel_hi:[1,0,1]
    v_pk_fma_f32 v[186:187], v[186:187], v[10:11], v[218:219] op_sel_hi:[1,0,1]
    v_cvt_pk_bf16_f32 v172, v172, v173
    v_cvt_pk_bf16_f32 v173, v174, v175
    v_cvt_pk_bf16_f32 v174, v176, v177
    v_cvt_pk_bf16_f32 v175, v178, v179
    v_cvt_pk_bf16_f32 v176, v180, v181
    v_cvt_pk_bf16_f32 v177, v182, v183
    v_cvt_pk_bf16_f32 v178, v184, v185
    v_cvt_pk_bf16_f32 v179, v186, v187
    v_pk_max_i16 v172, v172, 0
    v_pk_max_i16 v173, v173, 0
    v_pk_max_i16 v174, v174, 0
    v_pk_max_i16 v175, v175, 0
    v_pk_max_i16 v176, v176, 0
    v_pk_max_i16 v177, v177, 0
    v_pk_max_i16 v178, v178, 0
    v_pk_max_i16 v179, v179, 0
    buffer_store_dwordx4 v[172:175], v2, s[28:31], s61 offen offset:0
    buffer_store_dwordx4 v[176:179], v2, s[28:31], s61 offen offset:32
    s_nop 1
    v_mfma_f32_32x32x16_bf16 v[172:187], a[0:3], v[48:51], 0
    v_mfma_f32_32x32x16_bf16 v[172:187], a[4:7], v[52:55], v[172:187]
    v_mfma_f32_32x32x16_bf16 v[172:187], a[8:11], v[56:59], v[172:187]
    v_mfma_f32_32x32x16_bf16 v[172:187], a[12:15], v[60:63], v[172:187]
    s_nop 11
    v_cvt_pk_bf16_f32 v172, v172, v173
    v_cvt_pk_bf16_f32 v173, v174, v175
    v_cvt_pk_bf16_f32 v174, v176, v177
    v_cvt_pk_bf16_f32 v175, v178, v179
    v_cvt_pk_bf16_f32 v176, v180, v181
    v_cvt_pk_bf16_f32 v177, v182, v183
    v_cvt_pk_bf16_f32 v178, v184, v185
    v_cvt_pk_bf16_f32 v179, v186, v187
    v_mfma_f32_32x32x16_bf16 v[188:203], v[80:83], v[172:175], 0
    s_nop 0
    v_mfma_f32_32x32x16_bf16 v[188:203], v[84:87], v[176:179], v[188:203]
    v_mfma_f32_32x32x16_bf16 v[204:219], v[88:91], v[172:175], 0
    v_mfma_f32_32x32x16_bf16 v[204:219], v[92:95], v[176:179], v[204:219]
    v_mfma_f32_32x32x16_bf16 v[220:235], v[96:99], v[172:175], 0
    v_mfma_f32_32x32x16_bf16 v[220:235], v[100:103], v[176:179], v[220:235]
    v_mfma_f32_32x32x16_bf16 v[236:251], v[104:107], v[172:175], 0
    v_mfma_f32_32x32x16_bf16 v[236:251], v[108:111], v[176:179], v[236:251]
    s_nop 11
    v_cndmask_b32 v236, v236, v5, s[56:57]
    v_cndmask_b32 v237, v237, v5, s[56:57]
    v_cndmask_b32 v238, v238, v5, s[56:57]
    v_cndmask_b32 v239, v239, v5, s[56:57]
    v_max3_f32 v8, v188, v189, v190
    v_max3_f32 v8, v8, v191, v192
    v_max3_f32 v8, v8, v193, v194
    v_max3_f32 v8, v8, v195, v196
    v_max3_f32 v8, v8, v197, v198
    v_max3_f32 v8, v8, v199, v200
    v_max3_f32 v8, v8, v201, v202
    v_max3_f32 v8, v8, v203, v204
    v_max3_f32 v8, v8, v205, v206
    v_max3_f32 v8, v8, v207, v208
    v_max3_f32 v8, v8, v209, v210
    v_max3_f32 v8, v8, v211, v212
    v_max3_f32 v8, v8, v213, v214
    v_max3_f32 v8, v8, v215, v216
    v_max3_f32 v8, v8, v217, v218
    v_max3_f32 v8, v8, v219, v220
    v_max3_f32 v8, v8, v221, v222
    v_max3_f32 v8, v8, v223, v224
    v_max3_f32 v8, v8, v225, v226
    v_max3_f32 v8, v8, v227, v228
    v_max3_f32 v8, v8, v229, v230
    v_max3_f32 v8, v8, v231, v232
    v_max3_f32 v8, v8, v233, v234
    v_max3_f32 v8, v8, v235, v236
    v_max3_f32 v8, v8, v237, v238
    v_max_f32 v8, v8, v239
    v_mov_b32 v9, v8
    s_nop 1
    v_permlane32_swap_b32 v9, v8
    v_max_f32 v8, v8, v9
    v_pk_add_f32 v[188:189], v[188:189], v[8:9] op_sel_hi:[1,0] neg_lo:[0,1] neg_hi:[0,1]
    v_pk_add_f32 v[190:191], v[190:191], v[8:9] op_sel_hi:[1,0] neg_lo:[0,1] neg_hi:[0,1]
    v_pk_add_f32 v[192:193], v[192:193], v[8:9] op_sel_hi:[1,0] neg_lo:[0,1] neg_hi:[0,1]
    v_pk_add_f32 v[194:195], v[194:195], v[8:9] op_sel_hi:[1,0] neg_lo:[0,1] neg_hi:[0,1]
    v_pk_add_f32 v[196:197], v[196:197], v[8:9] op_sel_hi:[1,0] neg_lo:[0,1] neg_hi:[0,1]
    v_pk_add_f32 v[198:199], v[198:199], v[8:9] op_sel_hi:[1,0] neg_lo:[0,1] neg_hi:[0,1]
    v_pk_add_f32 v[200:201], v[200:201], v[8:9] op_sel_hi:[1,0] neg_lo:[0,1] neg_hi:[0,1]
    v_pk_add_f32 v[202:203], v[202:203], v[8:9] op_sel_hi:[1,0] neg_lo:[0,1] neg_hi:[0,1]
    v_pk_add_f32 v[204:205], v[204:205], v[8:9] op_sel_hi:[1,0] neg_lo:[0,1] neg_hi:[0,1]
    v_pk_add_f32 v[206:207], v[206:207], v[8:9] op_sel_hi:[1,0] neg_lo:[0,1] neg_hi:[0,1]
    v_pk_add_f32 v[208:209], v[208:209], v[8:9] op_sel_hi:[1,0] neg_lo:[0,1] neg_hi:[0,1]
    v_pk_add_f32 v[210:211], v[210:211], v[8:9] op_sel_hi:[1,0] neg_lo:[0,1] neg_hi:[0,1]
    v_pk_add_f32 v[212:213], v[212:213], v[8:9] op_sel_hi:[1,0] neg_lo:[0,1] neg_hi:[0,1]
    v_pk_add_f32 v[214:215], v[214:215], v[8:9] op_sel_hi:[1,0] neg_lo:[0,1] neg_hi:[0,1]
    v_pk_add_f32 v[216:217], v[216:217], v[8:9] op_sel_hi:[1,0] neg_lo:[0,1] neg_hi:[0,1]
    v_pk_add_f32 v[218:219], v[218:219], v[8:9] op_sel_hi:[1,0] neg_lo:[0,1] neg_hi:[0,1]
    v_pk_add_f32 v[220:221], v[220:221], v[8:9] op_sel_hi:[1,0] neg_lo:[0,1] neg_hi:[0,1]
    v_pk_add_f32 v[222:223], v[222:223], v[8:9] op_sel_hi:[1,0] neg_lo:[0,1] neg_hi:[0,1]
    v_pk_add_f32 v[224:225], v[224:225], v[8:9] op_sel_hi:[1,0] neg_lo:[0,1] neg_hi:[0,1]
    v_pk_add_f32 v[226:227], v[226:227], v[8:9] op_sel_hi:[1,0] neg_lo:[0,1] neg_hi:[0,1]
    v_pk_add_f32 v[228:229], v[228:229], v[8:9] op_sel_hi:[1,0] neg_lo:[0,1] neg_hi:[0,1]
    v_pk_add_f32 v[230:231], v[230:231], v[8:9] op_sel_hi:[1,0] neg_lo:[0,1] neg_hi:[0,1]
    v_pk_add_f32 v[232:233], v[232:233], v[8:9] op_sel_hi:[1,0] neg_lo:[0,1] neg_hi:[0,1]
    v_pk_add_f32 v[234:235], v[234:235], v[8:9] op_sel_hi:[1,0] neg_lo:[0,1] neg_hi:[0,1]
    v_pk_add_f32 v[236:237], v[236:237], v[8:9] op_sel_hi:[1,0] neg_lo:[0,1] neg_hi:[0,1]
    v_pk_add_f32 v[238:239], v[238:239], v[8:9] op_sel_hi:[1,0] neg_lo:[0,1] neg_hi:[0,1]
    v_exp_f32 v188, v188
    v_exp_f32 v189, v189
    v_exp_f32 v190, v190
    v_exp_f32 v191, v191
    v_exp_f32 v192, v192
    v_exp_f32 v193, v193
    v_exp_f32 v194, v194
    v_exp_f32 v195, v195
    v_exp_f32 v196, v196
    v_exp_f32 v197, v197
    v_exp_f32 v198, v198
    v_exp_f32 v199, v199
    v_exp_f32 v200, v200
    v_exp_f32 v201, v201
    v_exp_f32 v202, v202
    v_exp_f32 v203, v203
    v_exp_f32 v204, v204
    v_exp_f32 v205, v205
    v_exp_f32 v206, v206
    v_exp_f32 v207, v207
    v_exp_f32 v208, v208
    v_exp_f32 v209, v209
    v_exp_f32 v210, v210
    v_exp_f32 v211, v211
    v_exp_f32 v212, v212
    v_exp_f32 v213, v213
    v_exp_f32 v214, v214
    v_exp_f32 v215, v215
    v_exp_f32 v216, v216
    v_exp_f32 v217, v217
    v_exp_f32 v218, v218
    v_exp_f32 v219, v219
    v_exp_f32 v220, v220
    v_exp_f32 v221, v221
    v_exp_f32 v222, v222
    v_exp_f32 v223, v223
    v_exp_f32 v224, v224
    v_exp_f32 v225, v225
    v_exp_f32 v226, v226
    v_exp_f32 v227, v227
    v_exp_f32 v228, v228
    v_exp_f32 v229, v229
    v_exp_f32 v230, v230
    v_exp_f32 v231, v231
    v_exp_f32 v232, v232
    v_exp_f32 v233, v233
    v_exp_f32 v234, v234
    v_exp_f32 v235, v235
    v_exp_f32 v236, v236
    v_exp_f32 v237, v237
    v_exp_f32 v238, v238
    v_exp_f32 v239, v239
    v_pk_add_f32 v[10:11], v[188:189], v[190:191]
    v_pk_add_f32 v[10:11], v[10:11], v[192:193]
    v_pk_add_f32 v[10:11], v[10:11], v[194:195]
    v_pk_add_f32 v[10:11], v[10:11], v[196:197]
    v_pk_add_f32 v[10:11], v[10:11], v[198:199]
    v_pk_add_f32 v[10:11], v[10:11], v[200:201]
    v_pk_add_f32 v[10:11], v[10:11], v[202:203]
    v_pk_add_f32 v[10:11], v[10:11], v[204:205]
    v_pk_add_f32 v[10:11], v[10:11], v[206:207]
    v_pk_add_f32 v[10:11], v[10:11], v[208:209]
    v_pk_add_f32 v[10:11], v[10:11], v[210:211]
    v_pk_add_f32 v[10:11], v[10:11], v[212:213]
    v_pk_add_f32 v[10:11], v[10:11], v[214:215]
    v_pk_add_f32 v[10:11], v[10:11], v[216:217]
    v_pk_add_f32 v[10:11], v[10:11], v[218:219]
    v_pk_add_f32 v[10:11], v[10:11], v[220:221]
    v_pk_add_f32 v[10:11], v[10:11], v[222:223]
    v_pk_add_f32 v[10:11], v[10:11], v[224:225]
    v_pk_add_f32 v[10:11], v[10:11], v[226:227]
    v_pk_add_f32 v[10:11], v[10:11], v[228:229]
    v_pk_add_f32 v[10:11], v[10:11], v[230:231]
    v_pk_add_f32 v[10:11], v[10:11], v[232:233]
    v_pk_add_f32 v[10:11], v[10:11], v[234:235]
    v_pk_add_f32 v[10:11], v[10:11], v[236:237]
    v_pk_add_f32 v[10:11], v[10:11], v[238:239]
    v_add_f32 v10, v10, v11
    v_mov_b32 v11, v10
    s_nop 1
    v_permlane32_swap_b32 v11, v10
    v_add_f32 v10, v10, v11
    v_rcp_f32 v10, v10
    v_cvt_pk_bf16_f32 v188, v188, v189
    v_cvt_pk_bf16_f32 v189, v190, v191
    v_cvt_pk_bf16_f32 v190, v192, v193
    v_cvt_pk_bf16_f32 v191, v194, v195
    v_cvt_pk_bf16_f32 v192, v196, v197
    v_cvt_pk_bf16_f32 v193, v198, v199
    v_cvt_pk_bf16_f32 v194, v200, v201
    v_cvt_pk_bf16_f32 v195, v202, v203
    v_cvt_pk_bf16_f32 v196, v204, v205
    v_cvt_pk_bf16_f32 v197, v206, v207
    v_cvt_pk_bf16_f32 v198, v208, v209
    v_cvt_pk_bf16_f32 v199, v210, v211
    v_cvt_pk_bf16_f32 v200, v212, v213
    v_cvt_pk_bf16_f32 v201, v214, v215
    v_cvt_pk_bf16_f32 v202, v216, v217
    v_cvt_pk_bf16_f32 v203, v218, v219
    v_cvt_pk_bf16_f32 v220, v220, v221
    v_cvt_pk_bf16_f32 v221, v222, v223
    v_cvt_pk_bf16_f32 v222, v224, v225
    v_cvt_pk_bf16_f32 v223, v226, v227
    v_cvt_pk_bf16_f32 v224, v228, v229
    v_cvt_pk_bf16_f32 v225, v230, v231
    v_cvt_pk_bf16_f32 v226, v232, v233
    v_cvt_pk_bf16_f32 v227, v234, v235
    v_cvt_pk_bf16_f32 v228, v236, v237
    v_cvt_pk_bf16_f32 v229, v238, v239
    v_mov_b32 v230, 0
    v_mov_b32 v231, 0
    v_mfma_f32_32x32x16_bf16 v[204:219], a[96:99], v[48:51], 0
    v_mfma_f32_32x32x16_bf16 v[204:219], a[100:103], v[52:55], v[204:219]
    v_mfma_f32_32x32x16_bf16 v[204:219], a[104:107], v[56:59], v[204:219]
    v_mfma_f32_32x32x16_bf16 v[204:219], a[108:111], v[60:63], v[204:219]
    v_mfma_f32_32x32x16_bf16 v[172:187], v[112:115], v[188:191], 0
    v_mfma_f32_32x32x16_bf16 v[172:187], v[116:119], v[192:195], v[172:187]
    v_mfma_f32_32x32x16_bf16 v[172:187], v[120:123], v[196:199], v[172:187]
    v_mfma_f32_32x32x16_bf16 v[172:187], v[124:127], v[200:203], v[172:187]
    v_mfma_f32_32x32x16_bf16 v[172:187], v[128:131], v[220:223], v[172:187]
    v_mfma_f32_32x32x16_bf16 v[172:187], v[132:135], v[224:227], v[172:187]
    v_mfma_f32_32x32x16_bf16 v[172:187], v[136:139], v[228:231], v[172:187]
    s_nop 11
    v_pk_fma_f32 v[172:173], v[172:173], v[10:11], v[204:205] op_sel_hi:[1,0,1]
    v_pk_fma_f32 v[174:175], v[174:175], v[10:11], v[206:207] op_sel_hi:[1,0,1]
    v_pk_fma_f32 v[176:177], v[176:177], v[10:11], v[208:209] op_sel_hi:[1,0,1]
    v_pk_fma_f32 v[178:179], v[178:179], v[10:11], v[210:211] op_sel_hi:[1,0,1]
    v_pk_fma_f32 v[180:181], v[180:181], v[10:11], v[212:213] op_sel_hi:[1,0,1]
    v_pk_fma_f32 v[182:183], v[182:183], v[10:11], v[214:215] op_sel_hi:[1,0,1]
    v_pk_fma_f32 v[184:185], v[184:185], v[10:11], v[216:217] op_sel_hi:[1,0,1]
    v_pk_fma_f32 v[186:187], v[186:187], v[10:11], v[218:219] op_sel_hi:[1,0,1]
    v_cvt_pk_bf16_f32 v172, v172, v173
    v_cvt_pk_bf16_f32 v173, v174, v175
    v_cvt_pk_bf16_f32 v174, v176, v177
    v_cvt_pk_bf16_f32 v175, v178, v179
    v_cvt_pk_bf16_f32 v176, v180, v181
    v_cvt_pk_bf16_f32 v177, v182, v183
    v_cvt_pk_bf16_f32 v178, v184, v185
    v_cvt_pk_bf16_f32 v179, v186, v187
    v_pk_max_i16 v172, v172, 0
    v_pk_max_i16 v173, v173, 0
    v_pk_max_i16 v174, v174, 0
    v_pk_max_i16 v175, v175, 0
    v_pk_max_i16 v176, v176, 0
    v_pk_max_i16 v177, v177, 0
    v_pk_max_i16 v178, v178, 0
    v_pk_max_i16 v179, v179, 0
    buffer_store_dwordx4 v[172:175], v2, s[28:31], s62 offen offset:0
    buffer_store_dwordx4 v[176:179], v2, s[28:31], s62 offen offset:32
    s_nop 1
    v_mfma_f32_32x32x16_bf16 v[172:187], a[0:3], v[64:67], 0
    v_mfma_f32_32x32x16_bf16 v[172:187], a[4:7], v[68:71], v[172:187]
    v_mfma_f32_32x32x16_bf16 v[172:187], a[8:11], v[72:75], v[172:187]
    v_mfma_f32_32x32x16_bf16 v[172:187], a[12:15], v[76:79], v[172:187]
    s_nop 11
    v_cvt_pk_bf16_f32 v172, v172, v173
    v_cvt_pk_bf16_f32 v173, v174, v175
    v_cvt_pk_bf16_f32 v174, v176, v177
    v_cvt_pk_bf16_f32 v175, v178, v179
    v_cvt_pk_bf16_f32 v176, v180, v181
    v_cvt_pk_bf16_f32 v177, v182, v183
    v_cvt_pk_bf16_f32 v178, v184, v185
    v_cvt_pk_bf16_f32 v179, v186, v187
    v_mfma_f32_32x32x16_bf16 v[188:203], v[80:83], v[172:175], 0
    s_nop 0
    v_mfma_f32_32x32x16_bf16 v[188:203], v[84:87], v[176:179], v[188:203]
    v_mfma_f32_32x32x16_bf16 v[204:219], v[88:91], v[172:175], 0
    v_mfma_f32_32x32x16_bf16 v[204:219], v[92:95], v[176:179], v[204:219]
    v_mfma_f32_32x32x16_bf16 v[220:235], v[96:99], v[172:175], 0
    v_mfma_f32_32x32x16_bf16 v[220:235], v[100:103], v[176:179], v[220:235]
    v_mfma_f32_32x32x16_bf16 v[236:251], v[104:107], v[172:175], 0
    v_mfma_f32_32x32x16_bf16 v[236:251], v[108:111], v[176:179], v[236:251]
    s_nop 11
    v_cndmask_b32 v236, v236, v5, s[56:57]
    v_cndmask_b32 v237, v237, v5, s[56:57]
    v_cndmask_b32 v238, v238, v5, s[56:57]
    v_cndmask_b32 v239, v239, v5, s[56:57]
    v_max3_f32 v8, v188, v189, v190
    v_max3_f32 v8, v8, v191, v192
    v_max3_f32 v8, v8, v193, v194
    v_max3_f32 v8, v8, v195, v196
    v_max3_f32 v8, v8, v197, v198
    v_max3_f32 v8, v8, v199, v200
    v_max3_f32 v8, v8, v201, v202
    v_max3_f32 v8, v8, v203, v204
    v_max3_f32 v8, v8, v205, v206
    v_max3_f32 v8, v8, v207, v208
    v_max3_f32 v8, v8, v209, v210
    v_max3_f32 v8, v8, v211, v212
    v_max3_f32 v8, v8, v213, v214
    v_max3_f32 v8, v8, v215, v216
    v_max3_f32 v8, v8, v217, v218
    v_max3_f32 v8, v8, v219, v220
    v_max3_f32 v8, v8, v221, v222
    v_max3_f32 v8, v8, v223, v224
    v_max3_f32 v8, v8, v225, v226
    v_max3_f32 v8, v8, v227, v228
    v_max3_f32 v8, v8, v229, v230
    v_max3_f32 v8, v8, v231, v232
    v_max3_f32 v8, v8, v233, v234
    v_max3_f32 v8, v8, v235, v236
    v_max3_f32 v8, v8, v237, v238
    v_max_f32 v8, v8, v239
    v_mov_b32 v9, v8
    s_nop 1
    v_permlane32_swap_b32 v9, v8
    v_max_f32 v8, v8, v9
    v_pk_add_f32 v[188:189], v[188:189], v[8:9] op_sel_hi:[1,0] neg_lo:[0,1] neg_hi:[0,1]
    v_pk_add_f32 v[190:191], v[190:191], v[8:9] op_sel_hi:[1,0] neg_lo:[0,1] neg_hi:[0,1]
    v_pk_add_f32 v[192:193], v[192:193], v[8:9] op_sel_hi:[1,0] neg_lo:[0,1] neg_hi:[0,1]
    v_pk_add_f32 v[194:195], v[194:195], v[8:9] op_sel_hi:[1,0] neg_lo:[0,1] neg_hi:[0,1]
    v_pk_add_f32 v[196:197], v[196:197], v[8:9] op_sel_hi:[1,0] neg_lo:[0,1] neg_hi:[0,1]
    v_pk_add_f32 v[198:199], v[198:199], v[8:9] op_sel_hi:[1,0] neg_lo:[0,1] neg_hi:[0,1]
    v_pk_add_f32 v[200:201], v[200:201], v[8:9] op_sel_hi:[1,0] neg_lo:[0,1] neg_hi:[0,1]
    v_pk_add_f32 v[202:203], v[202:203], v[8:9] op_sel_hi:[1,0] neg_lo:[0,1] neg_hi:[0,1]
    v_pk_add_f32 v[204:205], v[204:205], v[8:9] op_sel_hi:[1,0] neg_lo:[0,1] neg_hi:[0,1]
    v_pk_add_f32 v[206:207], v[206:207], v[8:9] op_sel_hi:[1,0] neg_lo:[0,1] neg_hi:[0,1]
    v_pk_add_f32 v[208:209], v[208:209], v[8:9] op_sel_hi:[1,0] neg_lo:[0,1] neg_hi:[0,1]
    v_pk_add_f32 v[210:211], v[210:211], v[8:9] op_sel_hi:[1,0] neg_lo:[0,1] neg_hi:[0,1]
    v_pk_add_f32 v[212:213], v[212:213], v[8:9] op_sel_hi:[1,0] neg_lo:[0,1] neg_hi:[0,1]
    v_pk_add_f32 v[214:215], v[214:215], v[8:9] op_sel_hi:[1,0] neg_lo:[0,1] neg_hi:[0,1]
    v_pk_add_f32 v[216:217], v[216:217], v[8:9] op_sel_hi:[1,0] neg_lo:[0,1] neg_hi:[0,1]
    v_pk_add_f32 v[218:219], v[218:219], v[8:9] op_sel_hi:[1,0] neg_lo:[0,1] neg_hi:[0,1]
    v_pk_add_f32 v[220:221], v[220:221], v[8:9] op_sel_hi:[1,0] neg_lo:[0,1] neg_hi:[0,1]
    v_pk_add_f32 v[222:223], v[222:223], v[8:9] op_sel_hi:[1,0] neg_lo:[0,1] neg_hi:[0,1]
    v_pk_add_f32 v[224:225], v[224:225], v[8:9] op_sel_hi:[1,0] neg_lo:[0,1] neg_hi:[0,1]
    v_pk_add_f32 v[226:227], v[226:227], v[8:9] op_sel_hi:[1,0] neg_lo:[0,1] neg_hi:[0,1]
    v_pk_add_f32 v[228:229], v[228:229], v[8:9] op_sel_hi:[1,0] neg_lo:[0,1] neg_hi:[0,1]
    v_pk_add_f32 v[230:231], v[230:231], v[8:9] op_sel_hi:[1,0] neg_lo:[0,1] neg_hi:[0,1]
    v_pk_add_f32 v[232:233], v[232:233], v[8:9] op_sel_hi:[1,0] neg_lo:[0,1] neg_hi:[0,1]
    v_pk_add_f32 v[234:235], v[234:235], v[8:9] op_sel_hi:[1,0] neg_lo:[0,1] neg_hi:[0,1]
    v_pk_add_f32 v[236:237], v[236:237], v[8:9] op_sel_hi:[1,0] neg_lo:[0,1] neg_hi:[0,1]
    v_pk_add_f32 v[238:239], v[238:239], v[8:9] op_sel_hi:[1,0] neg_lo:[0,1] neg_hi:[0,1]
    v_exp_f32 v188, v188
    v_exp_f32 v189, v189
    v_exp_f32 v190, v190
    v_exp_f32 v191, v191
    v_exp_f32 v192, v192
    v_exp_f32 v193, v193
    v_exp_f32 v194, v194
    v_exp_f32 v195, v195
    v_exp_f32 v196, v196
    v_exp_f32 v197, v197
    v_exp_f32 v198, v198
    v_exp_f32 v199, v199
    v_exp_f32 v200, v200
    v_exp_f32 v201, v201
    v_exp_f32 v202, v202
    v_exp_f32 v203, v203
    v_exp_f32 v204, v204
    v_exp_f32 v205, v205
    v_exp_f32 v206, v206
    v_exp_f32 v207, v207
    v_exp_f32 v208, v208
    v_exp_f32 v209, v209
    v_exp_f32 v210, v210
    v_exp_f32 v211, v211
    v_exp_f32 v212, v212
    v_exp_f32 v213, v213
    v_exp_f32 v214, v214
    v_exp_f32 v215, v215
    v_exp_f32 v216, v216
    v_exp_f32 v217, v217
    v_exp_f32 v218, v218
    v_exp_f32 v219, v219
    v_exp_f32 v220, v220
    v_exp_f32 v221, v221
    v_exp_f32 v222, v222
    v_exp_f32 v223, v223
    v_exp_f32 v224, v224
    v_exp_f32 v225, v225
    v_exp_f32 v226, v226
    v_exp_f32 v227, v227
    v_exp_f32 v228, v228
    v_exp_f32 v229, v229
    v_exp_f32 v230, v230
    v_exp_f32 v231, v231
    v_exp_f32 v232, v232
    v_exp_f32 v233, v233
    v_exp_f32 v234, v234
    v_exp_f32 v235, v235
    v_exp_f32 v236, v236
    v_exp_f32 v237, v237
    v_exp_f32 v238, v238
    v_exp_f32 v239, v239
    v_pk_add_f32 v[10:11], v[188:189], v[190:191]
    v_pk_add_f32 v[10:11], v[10:11], v[192:193]
    v_pk_add_f32 v[10:11], v[10:11], v[194:195]
    v_pk_add_f32 v[10:11], v[10:11], v[196:197]
    v_pk_add_f32 v[10:11], v[10:11], v[198:199]
    v_pk_add_f32 v[10:11], v[10:11], v[200:201]
    v_pk_add_f32 v[10:11], v[10:11], v[202:203]
    v_pk_add_f32 v[10:11], v[10:11], v[204:205]
    v_pk_add_f32 v[10:11], v[10:11], v[206:207]
    v_pk_add_f32 v[10:11], v[10:11], v[208:209]
    v_pk_add_f32 v[10:11], v[10:11], v[210:211]
    v_pk_add_f32 v[10:11], v[10:11], v[212:213]
    v_pk_add_f32 v[10:11], v[10:11], v[214:215]
    v_pk_add_f32 v[10:11], v[10:11], v[216:217]
    v_pk_add_f32 v[10:11], v[10:11], v[218:219]
    v_pk_add_f32 v[10:11], v[10:11], v[220:221]
    v_pk_add_f32 v[10:11], v[10:11], v[222:223]
    v_pk_add_f32 v[10:11], v[10:11], v[224:225]
    v_pk_add_f32 v[10:11], v[10:11], v[226:227]
    v_pk_add_f32 v[10:11], v[10:11], v[228:229]
    v_pk_add_f32 v[10:11], v[10:11], v[230:231]
    v_pk_add_f32 v[10:11], v[10:11], v[232:233]
    v_pk_add_f32 v[10:11], v[10:11], v[234:235]
    v_pk_add_f32 v[10:11], v[10:11], v[236:237]
    v_pk_add_f32 v[10:11], v[10:11], v[238:239]
    v_add_f32 v10, v10, v11
    v_mov_b32 v11, v10
    s_nop 1
    v_permlane32_swap_b32 v11, v10
    v_add_f32 v10, v10, v11
    v_rcp_f32 v10, v10
    v_cvt_pk_bf16_f32 v188, v188, v189
    v_cvt_pk_bf16_f32 v189, v190, v191
    v_cvt_pk_bf16_f32 v190, v192, v193
    v_cvt_pk_bf16_f32 v191, v194, v195
    v_cvt_pk_bf16_f32 v192, v196, v197
    v_cvt_pk_bf16_f32 v193, v198, v199
    v_cvt_pk_bf16_f32 v194, v200, v201
    v_cvt_pk_bf16_f32 v195, v202, v203
    v_cvt_pk_bf16_f32 v196, v204, v205
    v_cvt_pk_bf16_f32 v197, v206, v207
    v_cvt_pk_bf16_f32 v198, v208, v209
    v_cvt_pk_bf16_f32 v199, v210, v211
    v_cvt_pk_bf16_f32 v200, v212, v213
    v_cvt_pk_bf16_f32 v201, v214, v215
    v_cvt_pk_bf16_f32 v202, v216, v217
    v_cvt_pk_bf16_f32 v203, v218, v219
    v_cvt_pk_bf16_f32 v220, v220, v221
    v_cvt_pk_bf16_f32 v221, v222, v223
    v_cvt_pk_bf16_f32 v222, v224, v225
    v_cvt_pk_bf16_f32 v223, v226, v227
    v_cvt_pk_bf16_f32 v224, v228, v229
    v_cvt_pk_bf16_f32 v225, v230, v231
    v_cvt_pk_bf16_f32 v226, v232, v233
    v_cvt_pk_bf16_f32 v227, v234, v235
    v_cvt_pk_bf16_f32 v228, v236, v237
    v_cvt_pk_bf16_f32 v229, v238, v239
    v_mov_b32 v230, 0
    v_mov_b32 v231, 0
    v_mfma_f32_32x32x16_bf16 v[204:219], a[96:99], v[64:67], 0
    v_mfma_f32_32x32x16_bf16 v[204:219], a[100:103], v[68:71], v[204:219]
    v_mfma_f32_32x32x16_bf16 v[204:219], a[104:107], v[72:75], v[204:219]
    v_mfma_f32_32x32x16_bf16 v[204:219], a[108:111], v[76:79], v[204:219]
    v_mfma_f32_32x32x16_bf16 v[172:187], v[112:115], v[188:191], 0
    v_mfma_f32_32x32x16_bf16 v[172:187], v[116:119], v[192:195], v[172:187]
    v_mfma_f32_32x32x16_bf16 v[172:187], v[120:123], v[196:199], v[172:187]
    v_mfma_f32_32x32x16_bf16 v[172:187], v[124:127], v[200:203], v[172:187]
    v_mfma_f32_32x32x16_bf16 v[172:187], v[128:131], v[220:223], v[172:187]
    v_mfma_f32_32x32x16_bf16 v[172:187], v[132:135], v[224:227], v[172:187]
    v_mfma_f32_32x32x16_bf16 v[172:187], v[136:139], v[228:231], v[172:187]
    s_nop 11
    v_pk_fma_f32 v[172:173], v[172:173], v[10:11], v[204:205] op_sel_hi:[1,0,1]
    v_pk_fma_f32 v[174:175], v[174:175], v[10:11], v[206:207] op_sel_hi:[1,0,1]
    v_pk_fma_f32 v[176:177], v[176:177], v[10:11], v[208:209] op_sel_hi:[1,0,1]
    v_pk_fma_f32 v[178:179], v[178:179], v[10:11], v[210:211] op_sel_hi:[1,0,1]
    v_pk_fma_f32 v[180:181], v[180:181], v[10:11], v[212:213] op_sel_hi:[1,0,1]
    v_pk_fma_f32 v[182:183], v[182:183], v[10:11], v[214:215] op_sel_hi:[1,0,1]
    v_pk_fma_f32 v[184:185], v[184:185], v[10:11], v[216:217] op_sel_hi:[1,0,1]
    v_pk_fma_f32 v[186:187], v[186:187], v[10:11], v[218:219] op_sel_hi:[1,0,1]
    v_cvt_pk_bf16_f32 v172, v172, v173
    v_cvt_pk_bf16_f32 v173, v174, v175
    v_cvt_pk_bf16_f32 v174, v176, v177
    v_cvt_pk_bf16_f32 v175, v178, v179
    v_cvt_pk_bf16_f32 v176, v180, v181
    v_cvt_pk_bf16_f32 v177, v182, v183
    v_cvt_pk_bf16_f32 v178, v184, v185
    v_cvt_pk_bf16_f32 v179, v186, v187
    v_pk_max_i16 v172, v172, 0
    v_pk_max_i16 v173, v173, 0
    v_pk_max_i16 v174, v174, 0
    v_pk_max_i16 v175, v175, 0
    v_pk_max_i16 v176, v176, 0
    v_pk_max_i16 v177, v177, 0
    v_pk_max_i16 v178, v178, 0
    v_pk_max_i16 v179, v179, 0
    buffer_store_dwordx4 v[172:175], v3, s[28:31], s63 offen offset:0
    buffer_store_dwordx4 v[176:179], v3, s[28:31], s63 offen offset:32
    v_mfma_f32_32x32x16_bf16 v[188:203], a[48:51], v[16:19], 0
    v_mfma_f32_32x32x16_bf16 v[188:203], a[52:55], v[20:23], v[188:203]
    v_mfma_f32_32x32x16_bf16 v[188:203], a[56:59], v[24:27], v[188:203]
    v_mfma_f32_32x32x16_bf16 v[188:203], a[60:63], v[28:31], v[188:203]
    v_mfma_f32_32x32x16_bf16 v[204:219], a[48:51], v[32:35], 0
    v_mfma_f32_32x32x16_bf16 v[204:219], a[52:55], v[36:39], v[204:219]
    v_mfma_f32_32x32x16_bf16 v[204:219], a[56:59], v[40:43], v[204:219]
    v_mfma_f32_32x32x16_bf16 v[204:219], a[60:63], v[44:47], v[204:219]
    v_mfma_f32_32x32x16_bf16 v[220:235], a[48:51], v[48:51], 0
    v_mfma_f32_32x32x16_bf16 v[220:235], a[52:55], v[52:55], v[220:235]
    v_mfma_f32_32x32x16_bf16 v[220:235], a[56:59], v[56:59], v[220:235]
    v_mfma_f32_32x32x16_bf16 v[220:235], a[60:63], v[60:63], v[220:235]
    v_mfma_f32_32x32x16_bf16 v[236:251], a[48:51], v[64:67], 0
    v_mfma_f32_32x32x16_bf16 v[236:251], a[52:55], v[68:71], v[236:251]
    v_mfma_f32_32x32x16_bf16 v[236:251], a[56:59], v[72:75], v[236:251]
    v_mfma_f32_32x32x16_bf16 v[236:251], a[60:63], v[76:79], v[236:251]
    v_cvt_pk_bf16_f32 v80, v188, v189
    v_cvt_pk_bf16_f32 v81, v190, v191
    v_cvt_pk_bf16_f32 v82, v192, v193
    v_cvt_pk_bf16_f32 v83, v194, v195
    v_cvt_pk_bf16_f32 v84, v196, v197
    v_cvt_pk_bf16_f32 v85, v198, v199
    v_cvt_pk_bf16_f32 v86, v200, v201
    v_cvt_pk_bf16_f32 v87, v202, v203
    v_cvt_pk_bf16_f32 v88, v204, v205
    v_cvt_pk_bf16_f32 v89, v206, v207
    v_cvt_pk_bf16_f32 v90, v208, v209
    v_cvt_pk_bf16_f32 v91, v210, v211
    v_cvt_pk_bf16_f32 v92, v212, v213
    v_cvt_pk_bf16_f32 v93, v214, v215
    v_cvt_pk_bf16_f32 v94, v216, v217
    v_cvt_pk_bf16_f32 v95, v218, v219
    v_cvt_pk_bf16_f32 v96, v220, v221
    v_cvt_pk_bf16_f32 v97, v222, v223
    v_cvt_pk_bf16_f32 v98, v224, v225
    v_cvt_pk_bf16_f32 v99, v226, v227
    v_cvt_pk_bf16_f32 v100, v228, v229
    v_cvt_pk_bf16_f32 v101, v230, v231
    v_cvt_pk_bf16_f32 v102, v232, v233
    v_cvt_pk_bf16_f32 v103, v234, v235
    v_cvt_pk_bf16_f32 v104, v236, v237
    v_cvt_pk_bf16_f32 v105, v238, v239
    v_cvt_pk_bf16_f32 v106, v240, v241
    v_cvt_pk_bf16_f32 v107, v242, v243
    v_cvt_pk_bf16_f32 v108, v244, v245
    v_cvt_pk_bf16_f32 v109, v246, v247
    v_cvt_pk_bf16_f32 v110, v248, v249
    v_cvt_pk_bf16_f32 v111, v250, v251
    v_mfma_f32_32x32x16_bf16 v[188:203], v[16:19], a[80:83], 0
    v_mfma_f32_32x32x16_bf16 v[188:203], v[20:23], a[84:87], v[188:203]
    v_mfma_f32_32x32x16_bf16 v[188:203], v[24:27], a[88:91], v[188:203]
    v_mfma_f32_32x32x16_bf16 v[188:203], v[28:31], a[92:95], v[188:203]
    v_mfma_f32_32x32x16_bf16 v[204:219], v[32:35], a[80:83], 0
    v_mfma_f32_32x32x16_bf16 v[204:219], v[36:39], a[84:87], v[204:219]
    v_mfma_f32_32x32x16_bf16 v[204:219], v[40:43], a[88:91], v[204:219]
    v_mfma_f32_32x32x16_bf16 v[204:219], v[44:47], a[92:95], v[204:219]
    v_mfma_f32_32x32x16_bf16 v[220:235], v[48:51], a[80:83], 0
    v_mfma_f32_32x32x16_bf16 v[220:235], v[52:55], a[84:87], v[220:235]
    v_mfma_f32_32x32x16_bf16 v[220:235], v[56:59], a[88:91], v[220:235]
    v_mfma_f32_32x32x16_bf16 v[220:235], v[60:63], a[92:95], v[220:235]
    v_mfma_f32_32x32x16_bf16 v[236:251], v[64:67], a[80:83], 0
    v_mfma_f32_32x32x16_bf16 v[236:251], v[68:71], a[84:87], v[236:251]
    v_mfma_f32_32x32x16_bf16 v[236:251], v[72:75], a[88:91], v[236:251]
    v_mfma_f32_32x32x16_bf16 v[236:251], v[76:79], a[92:95], v[236:251]
    v_cvt_pk_bf16_f32 v112, v188, v189
    v_cvt_pk_bf16_f32 v113, v190, v191
    v_cvt_pk_bf16_f32 v114, v192, v193
    v_cvt_pk_bf16_f32 v115, v194, v195
    v_cvt_pk_bf16_f32 v116, v196, v197
    v_cvt_pk_bf16_f32 v117, v198, v199
    v_cvt_pk_bf16_f32 v118, v200, v201
    v_cvt_pk_bf16_f32 v119, v202, v203
    v_cvt_pk_bf16_f32 v120, v204, v205
    v_cvt_pk_bf16_f32 v121, v206, v207
    v_cvt_pk_bf16_f32 v122, v208, v209
    v_cvt_pk_bf16_f32 v123, v210, v211
    v_cvt_pk_bf16_f32 v124, v212, v213
    v_cvt_pk_bf16_f32 v125, v214, v215
    v_cvt_pk_bf16_f32 v126, v216, v217
    v_cvt_pk_bf16_f32 v127, v218, v219
    v_cvt_pk_bf16_f32 v128, v220, v221
    v_cvt_pk_bf16_f32 v129, v222, v223
    v_cvt_pk_bf16_f32 v130, v224, v225
    v_cvt_pk_bf16_f32 v131, v226, v227
    v_cvt_pk_bf16_f32 v132, v228, v229
    v_cvt_pk_bf16_f32 v133, v230, v231
    v_cvt_pk_bf16_f32 v134, v232, v233
    v_cvt_pk_bf16_f32 v135, v234, v235
    v_cvt_pk_bf16_f32 v136, v236, v237
    v_cvt_pk_bf16_f32 v137, v238, v239
    v_cvt_pk_bf16_f32 v138, v240, v241
    v_cvt_pk_bf16_f32 v139, v242, v243
    v_mfma_f32_32x32x16_bf16 v[172:187], a[16:19], v[16:19], 0
    v_mfma_f32_32x32x16_bf16 v[172:187], a[20:23], v[20:23], v[172:187]
    v_mfma_f32_32x32x16_bf16 v[172:187], a[24:27], v[24:27], v[172:187]
    v_mfma_f32_32x32x16_bf16 v[172:187], a[28:31], v[28:31], v[172:187]
    s_nop 11
    v_cvt_pk_bf16_f32 v172, v172, v173
    v_cvt_pk_bf16_f32 v173, v174, v175
    v_cvt_pk_bf16_f32 v174, v176, v177
    v_cvt_pk_bf16_f32 v175, v178, v179
    v_cvt_pk_bf16_f32 v176, v180, v181
    v_cvt_pk_bf16_f32 v177, v182, v183
    v_cvt_pk_bf16_f32 v178, v184, v185
    v_cvt_pk_bf16_f32 v179, v186, v187
    v_mfma_f32_32x32x16_bf16 v[188:203], v[80:83], v[172:175], 0
    s_nop 0
    v_mfma_f32_32x32x16_bf16 v[188:203], v[84:87], v[176:179], v[188:203]
    v_mfma_f32_32x32x16_bf16 v[204:219], v[88:91], v[172:175], 0
    v_mfma_f32_32x32x16_bf16 v[204:219], v[92:95], v[176:179], v[204:219]
    v_mfma_f32_32x32x16_bf16 v[220:235], v[96:99], v[172:175], 0
    v_mfma_f32_32x32x16_bf16 v[220:235], v[100:103], v[176:179], v[220:235]
    v_mfma_f32_32x32x16_bf16 v[236:251], v[104:107], v[172:175], 0
    v_mfma_f32_32x32x16_bf16 v[236:251], v[108:111], v[176:179], v[236:251]
    s_nop 11
    v_cndmask_b32 v236, v236, v5, s[56:57]
    v_cndmask_b32 v237, v237, v5, s[56:57]
    v_cndmask_b32 v238, v238, v5, s[56:57]
    v_cndmask_b32 v239, v239, v5, s[56:57]
    v_max3_f32 v8, v188, v189, v190
    v_max3_f32 v8, v8, v191, v192
    v_max3_f32 v8, v8, v193, v194
    v_max3_f32 v8, v8, v195, v196
    v_max3_f32 v8, v8, v197, v198
    v_max3_f32 v8, v8, v199, v200
    v_max3_f32 v8, v8, v201, v202
    v_max3_f32 v8, v8, v203, v204
    v_max3_f32 v8, v8, v205, v206
    v_max3_f32 v8, v8, v207, v208
    v_max3_f32 v8, v8, v209, v210
    v_max3_f32 v8, v8, v211, v212
    v_max3_f32 v8, v8, v213, v214
    v_max3_f32 v8, v8, v215, v216
    v_max3_f32 v8, v8, v217, v218
    v_max3_f32 v8, v8, v219, v220
    v_max3_f32 v8, v8, v221, v222
    v_max3_f32 v8, v8, v223, v224
    v_max3_f32 v8, v8, v225, v226
    v_max3_f32 v8, v8, v227, v228
    v_max3_f32 v8, v8, v229, v230
    v_max3_f32 v8, v8, v231, v232
    v_max3_f32 v8, v8, v233, v234
    v_max3_f32 v8, v8, v235, v236
    v_max3_f32 v8, v8, v237, v238
    v_max_f32 v8, v8, v239
    v_mov_b32 v9, v8
    s_nop 1
    v_permlane32_swap_b32 v9, v8
    v_max_f32 v8, v8, v9
    v_pk_add_f32 v[188:189], v[188:189], v[8:9] op_sel_hi:[1,0] neg_lo:[0,1] neg_hi:[0,1]
    v_pk_add_f32 v[190:191], v[190:191], v[8:9] op_sel_hi:[1,0] neg_lo:[0,1] neg_hi:[0,1]
    v_pk_add_f32 v[192:193], v[192:193], v[8:9] op_sel_hi:[1,0] neg_lo:[0,1] neg_hi:[0,1]
    v_pk_add_f32 v[194:195], v[194:195], v[8:9] op_sel_hi:[1,0] neg_lo:[0,1] neg_hi:[0,1]
    v_pk_add_f32 v[196:197], v[196:197], v[8:9] op_sel_hi:[1,0] neg_lo:[0,1] neg_hi:[0,1]
    v_pk_add_f32 v[198:199], v[198:199], v[8:9] op_sel_hi:[1,0] neg_lo:[0,1] neg_hi:[0,1]
    v_pk_add_f32 v[200:201], v[200:201], v[8:9] op_sel_hi:[1,0] neg_lo:[0,1] neg_hi:[0,1]
    v_pk_add_f32 v[202:203], v[202:203], v[8:9] op_sel_hi:[1,0] neg_lo:[0,1] neg_hi:[0,1]
    v_pk_add_f32 v[204:205], v[204:205], v[8:9] op_sel_hi:[1,0] neg_lo:[0,1] neg_hi:[0,1]
    v_pk_add_f32 v[206:207], v[206:207], v[8:9] op_sel_hi:[1,0] neg_lo:[0,1] neg_hi:[0,1]
    v_pk_add_f32 v[208:209], v[208:209], v[8:9] op_sel_hi:[1,0] neg_lo:[0,1] neg_hi:[0,1]
    v_pk_add_f32 v[210:211], v[210:211], v[8:9] op_sel_hi:[1,0] neg_lo:[0,1] neg_hi:[0,1]
    v_pk_add_f32 v[212:213], v[212:213], v[8:9] op_sel_hi:[1,0] neg_lo:[0,1] neg_hi:[0,1]
    v_pk_add_f32 v[214:215], v[214:215], v[8:9] op_sel_hi:[1,0] neg_lo:[0,1] neg_hi:[0,1]
    v_pk_add_f32 v[216:217], v[216:217], v[8:9] op_sel_hi:[1,0] neg_lo:[0,1] neg_hi:[0,1]
    v_pk_add_f32 v[218:219], v[218:219], v[8:9] op_sel_hi:[1,0] neg_lo:[0,1] neg_hi:[0,1]
    v_pk_add_f32 v[220:221], v[220:221], v[8:9] op_sel_hi:[1,0] neg_lo:[0,1] neg_hi:[0,1]
    v_pk_add_f32 v[222:223], v[222:223], v[8:9] op_sel_hi:[1,0] neg_lo:[0,1] neg_hi:[0,1]
    v_pk_add_f32 v[224:225], v[224:225], v[8:9] op_sel_hi:[1,0] neg_lo:[0,1] neg_hi:[0,1]
    v_pk_add_f32 v[226:227], v[226:227], v[8:9] op_sel_hi:[1,0] neg_lo:[0,1] neg_hi:[0,1]
    v_pk_add_f32 v[228:229], v[228:229], v[8:9] op_sel_hi:[1,0] neg_lo:[0,1] neg_hi:[0,1]
    v_pk_add_f32 v[230:231], v[230:231], v[8:9] op_sel_hi:[1,0] neg_lo:[0,1] neg_hi:[0,1]
    v_pk_add_f32 v[232:233], v[232:233], v[8:9] op_sel_hi:[1,0] neg_lo:[0,1] neg_hi:[0,1]
    v_pk_add_f32 v[234:235], v[234:235], v[8:9] op_sel_hi:[1,0] neg_lo:[0,1] neg_hi:[0,1]
    v_pk_add_f32 v[236:237], v[236:237], v[8:9] op_sel_hi:[1,0] neg_lo:[0,1] neg_hi:[0,1]
    v_pk_add_f32 v[238:239], v[238:239], v[8:9] op_sel_hi:[1,0] neg_lo:[0,1] neg_hi:[0,1]
    v_exp_f32 v188, v188
    v_exp_f32 v189, v189
    v_exp_f32 v190, v190
    v_exp_f32 v191, v191
    v_exp_f32 v192, v192
    v_exp_f32 v193, v193
    v_exp_f32 v194, v194
    v_exp_f32 v195, v195
    v_exp_f32 v196, v196
    v_exp_f32 v197, v197
    v_exp_f32 v198, v198
    v_exp_f32 v199, v199
    v_exp_f32 v200, v200
    v_exp_f32 v201, v201
    v_exp_f32 v202, v202
    v_exp_f32 v203, v203
    v_exp_f32 v204, v204
    v_exp_f32 v205, v205
    v_exp_f32 v206, v206
    v_exp_f32 v207, v207
    v_exp_f32 v208, v208
    v_exp_f32 v209, v209
    v_exp_f32 v210, v210
    v_exp_f32 v211, v211
    v_exp_f32 v212, v212
    v_exp_f32 v213, v213
    v_exp_f32 v214, v214
    v_exp_f32 v215, v215
    v_exp_f32 v216, v216
    v_exp_f32 v217, v217
    v_exp_f32 v218, v218
    v_exp_f32 v219, v219
    v_exp_f32 v220, v220
    v_exp_f32 v221, v221
    v_exp_f32 v222, v222
    v_exp_f32 v223, v223
    v_exp_f32 v224, v224
    v_exp_f32 v225, v225
    v_exp_f32 v226, v226
    v_exp_f32 v227, v227
    v_exp_f32 v228, v228
    v_exp_f32 v229, v229
    v_exp_f32 v230, v230
    v_exp_f32 v231, v231
    v_exp_f32 v232, v232
    v_exp_f32 v233, v233
    v_exp_f32 v234, v234
    v_exp_f32 v235, v235
    v_exp_f32 v236, v236
    v_exp_f32 v237, v237
    v_exp_f32 v238, v238
    v_exp_f32 v239, v239
    v_pk_add_f32 v[10:11], v[188:189], v[190:191]
    v_pk_add_f32 v[10:11], v[10:11], v[192:193]
    v_pk_add_f32 v[10:11], v[10:11], v[194:195]
    v_pk_add_f32 v[10:11], v[10:11], v[196:197]
    v_pk_add_f32 v[10:11], v[10:11], v[198:199]
    v_pk_add_f32 v[10:11], v[10:11], v[200:201]
    v_pk_add_f32 v[10:11], v[10:11], v[202:203]
    v_pk_add_f32 v[10:11], v[10:11], v[204:205]
    v_pk_add_f32 v[10:11], v[10:11], v[206:207]
    v_pk_add_f32 v[10:11], v[10:11], v[208:209]
    v_pk_add_f32 v[10:11], v[10:11], v[210:211]
    v_pk_add_f32 v[10:11], v[10:11], v[212:213]
    v_pk_add_f32 v[10:11], v[10:11], v[214:215]
    v_pk_add_f32 v[10:11], v[10:11], v[216:217]
    v_pk_add_f32 v[10:11], v[10:11], v[218:219]
    v_pk_add_f32 v[10:11], v[10:11], v[220:221]
    v_pk_add_f32 v[10:11], v[10:11], v[222:223]
    v_pk_add_f32 v[10:11], v[10:11], v[224:225]
    v_pk_add_f32 v[10:11], v[10:11], v[226:227]
    v_pk_add_f32 v[10:11], v[10:11], v[228:229]
    v_pk_add_f32 v[10:11], v[10:11], v[230:231]
    v_pk_add_f32 v[10:11], v[10:11], v[232:233]
    v_pk_add_f32 v[10:11], v[10:11], v[234:235]
    v_pk_add_f32 v[10:11], v[10:11], v[236:237]
    v_pk_add_f32 v[10:11], v[10:11], v[238:239]
    v_add_f32 v10, v10, v11
    v_mov_b32 v11, v10
    s_nop 1
    v_permlane32_swap_b32 v11, v10
    v_add_f32 v10, v10, v11
    v_rcp_f32 v10, v10
    v_cvt_pk_bf16_f32 v188, v188, v189
    v_cvt_pk_bf16_f32 v189, v190, v191
    v_cvt_pk_bf16_f32 v190, v192, v193
    v_cvt_pk_bf16_f32 v191, v194, v195
    v_cvt_pk_bf16_f32 v192, v196, v197
    v_cvt_pk_bf16_f32 v193, v198, v199
    v_cvt_pk_bf16_f32 v194, v200, v201
    v_cvt_pk_bf16_f32 v195, v202, v203
    v_cvt_pk_bf16_f32 v196, v204, v205
    v_cvt_pk_bf16_f32 v197, v206, v207
    v_cvt_pk_bf16_f32 v198, v208, v209
    v_cvt_pk_bf16_f32 v199, v210, v211
    v_cvt_pk_bf16_f32 v200, v212, v213
    v_cvt_pk_bf16_f32 v201, v214, v215
    v_cvt_pk_bf16_f32 v202, v216, v217
    v_cvt_pk_bf16_f32 v203, v218, v219
    v_cvt_pk_bf16_f32 v220, v220, v221
    v_cvt_pk_bf16_f32 v221, v222, v223
    v_cvt_pk_bf16_f32 v222, v224, v225
    v_cvt_pk_bf16_f32 v223, v226, v227
    v_cvt_pk_bf16_f32 v224, v228, v229
    v_cvt_pk_bf16_f32 v225, v230, v231
    v_cvt_pk_bf16_f32 v226, v232, v233
    v_cvt_pk_bf16_f32 v227, v234, v235
    v_cvt_pk_bf16_f32 v228, v236, v237
    v_cvt_pk_bf16_f32 v229, v238, v239
    v_mov_b32 v230, 0
    v_mov_b32 v231, 0
    v_mfma_f32_32x32x16_bf16 v[204:219], a[112:115], v[16:19], 0
    v_mfma_f32_32x32x16_bf16 v[204:219], a[116:119], v[20:23], v[204:219]
    v_mfma_f32_32x32x16_bf16 v[204:219], a[120:123], v[24:27], v[204:219]
    v_mfma_f32_32x32x16_bf16 v[204:219], a[124:127], v[28:31], v[204:219]
    v_mfma_f32_32x32x16_bf16 v[172:187], v[112:115], v[188:191], 0
    v_mfma_f32_32x32x16_bf16 v[172:187], v[116:119], v[192:195], v[172:187]
    v_mfma_f32_32x32x16_bf16 v[172:187], v[120:123], v[196:199], v[172:187]
    v_mfma_f32_32x32x16_bf16 v[172:187], v[124:127], v[200:203], v[172:187]
    v_mfma_f32_32x32x16_bf16 v[172:187], v[128:131], v[220:223], v[172:187]
    v_mfma_f32_32x32x16_bf16 v[172:187], v[132:135], v[224:227], v[172:187]
    v_mfma_f32_32x32x16_bf16 v[172:187], v[136:139], v[228:231], v[172:187]
    s_nop 11
    v_pk_fma_f32 v[172:173], v[172:173], v[10:11], v[204:205] op_sel_hi:[1,0,1]
    v_pk_fma_f32 v[174:175], v[174:175], v[10:11], v[206:207] op_sel_hi:[1,0,1]
    v_pk_fma_f32 v[176:177], v[176:177], v[10:11], v[208:209] op_sel_hi:[1,0,1]
    v_pk_fma_f32 v[178:179], v[178:179], v[10:11], v[210:211] op_sel_hi:[1,0,1]
    v_pk_fma_f32 v[180:181], v[180:181], v[10:11], v[212:213] op_sel_hi:[1,0,1]
    v_pk_fma_f32 v[182:183], v[182:183], v[10:11], v[214:215] op_sel_hi:[1,0,1]
    v_pk_fma_f32 v[184:185], v[184:185], v[10:11], v[216:217] op_sel_hi:[1,0,1]
    v_pk_fma_f32 v[186:187], v[186:187], v[10:11], v[218:219] op_sel_hi:[1,0,1]
    v_cvt_pk_bf16_f32 v172, v172, v173
    v_cvt_pk_bf16_f32 v173, v174, v175
    v_cvt_pk_bf16_f32 v174, v176, v177
    v_cvt_pk_bf16_f32 v175, v178, v179
    v_cvt_pk_bf16_f32 v176, v180, v181
    v_cvt_pk_bf16_f32 v177, v182, v183
    v_cvt_pk_bf16_f32 v178, v184, v185
    v_cvt_pk_bf16_f32 v179, v186, v187
    v_pk_max_i16 v172, v172, 0
    v_pk_max_i16 v173, v173, 0
    v_pk_max_i16 v174, v174, 0
    v_pk_max_i16 v175, v175, 0
    v_pk_max_i16 v176, v176, 0
    v_pk_max_i16 v177, v177, 0
    v_pk_max_i16 v178, v178, 0
    v_pk_max_i16 v179, v179, 0
    buffer_store_dwordx4 v[172:175], v2, s[28:31], s60 offen offset:64
    buffer_store_dwordx4 v[176:179], v2, s[28:31], s60 offen offset:96
    s_nop 1
    v_mfma_f32_32x32x16_bf16 v[172:187], a[16:19], v[32:35], 0
    v_mfma_f32_32x32x16_bf16 v[172:187], a[20:23], v[36:39], v[172:187]
    v_mfma_f32_32x32x16_bf16 v[172:187], a[24:27], v[40:43], v[172:187]
    v_mfma_f32_32x32x16_bf16 v[172:187], a[28:31], v[44:47], v[172:187]
    s_nop 11
    v_cvt_pk_bf16_f32 v172, v172, v173
    v_cvt_pk_bf16_f32 v173, v174, v175
    v_cvt_pk_bf16_f32 v174, v176, v177
    v_cvt_pk_bf16_f32 v175, v178, v179
    v_cvt_pk_bf16_f32 v176, v180, v181
    v_cvt_pk_bf16_f32 v177, v182, v183
    v_cvt_pk_bf16_f32 v178, v184, v185
    v_cvt_pk_bf16_f32 v179, v186, v187
    v_mfma_f32_32x32x16_bf16 v[188:203], v[80:83], v[172:175], 0
    s_nop 0
    v_mfma_f32_32x32x16_bf16 v[188:203], v[84:87], v[176:179], v[188:203]
    v_mfma_f32_32x32x16_bf16 v[204:219], v[88:91], v[172:175], 0
    v_mfma_f32_32x32x16_bf16 v[204:219], v[92:95], v[176:179], v[204:219]
    v_mfma_f32_32x32x16_bf16 v[220:235], v[96:99], v[172:175], 0
    v_mfma_f32_32x32x16_bf16 v[220:235], v[100:103], v[176:179], v[220:235]
    v_mfma_f32_32x32x16_bf16 v[236:251], v[104:107], v[172:175], 0
    v_mfma_f32_32x32x16_bf16 v[236:251], v[108:111], v[176:179], v[236:251]
    s_nop 11
    v_cndmask_b32 v236, v236, v5, s[56:57]
    v_cndmask_b32 v237, v237, v5, s[56:57]
    v_cndmask_b32 v238, v238, v5, s[56:57]
    v_cndmask_b32 v239, v239, v5, s[56:57]
    v_max3_f32 v8, v188, v189, v190
    v_max3_f32 v8, v8, v191, v192
    v_max3_f32 v8, v8, v193, v194
    v_max3_f32 v8, v8, v195, v196
    v_max3_f32 v8, v8, v197, v198
    v_max3_f32 v8, v8, v199, v200
    v_max3_f32 v8, v8, v201, v202
    v_max3_f32 v8, v8, v203, v204
    v_max3_f32 v8, v8, v205, v206
    v_max3_f32 v8, v8, v207, v208
    v_max3_f32 v8, v8, v209, v210
    v_max3_f32 v8, v8, v211, v212
    v_max3_f32 v8, v8, v213, v214
    v_max3_f32 v8, v8, v215, v216
    v_max3_f32 v8, v8, v217, v218
    v_max3_f32 v8, v8, v219, v220
    v_max3_f32 v8, v8, v221, v222
    v_max3_f32 v8, v8, v223, v224
    v_max3_f32 v8, v8, v225, v226
    v_max3_f32 v8, v8, v227, v228
    v_max3_f32 v8, v8, v229, v230
    v_max3_f32 v8, v8, v231, v232
    v_max3_f32 v8, v8, v233, v234
    v_max3_f32 v8, v8, v235, v236
    v_max3_f32 v8, v8, v237, v238
    v_max_f32 v8, v8, v239
    v_mov_b32 v9, v8
    s_nop 1
    v_permlane32_swap_b32 v9, v8
    v_max_f32 v8, v8, v9
    v_pk_add_f32 v[188:189], v[188:189], v[8:9] op_sel_hi:[1,0] neg_lo:[0,1] neg_hi:[0,1]
    v_pk_add_f32 v[190:191], v[190:191], v[8:9] op_sel_hi:[1,0] neg_lo:[0,1] neg_hi:[0,1]
    v_pk_add_f32 v[192:193], v[192:193], v[8:9] op_sel_hi:[1,0] neg_lo:[0,1] neg_hi:[0,1]
    v_pk_add_f32 v[194:195], v[194:195], v[8:9] op_sel_hi:[1,0] neg_lo:[0,1] neg_hi:[0,1]
    v_pk_add_f32 v[196:197], v[196:197], v[8:9] op_sel_hi:[1,0] neg_lo:[0,1] neg_hi:[0,1]
    v_pk_add_f32 v[198:199], v[198:199], v[8:9] op_sel_hi:[1,0] neg_lo:[0,1] neg_hi:[0,1]
    v_pk_add_f32 v[200:201], v[200:201], v[8:9] op_sel_hi:[1,0] neg_lo:[0,1] neg_hi:[0,1]
    v_pk_add_f32 v[202:203], v[202:203], v[8:9] op_sel_hi:[1,0] neg_lo:[0,1] neg_hi:[0,1]
    v_pk_add_f32 v[204:205], v[204:205], v[8:9] op_sel_hi:[1,0] neg_lo:[0,1] neg_hi:[0,1]
    v_pk_add_f32 v[206:207], v[206:207], v[8:9] op_sel_hi:[1,0] neg_lo:[0,1] neg_hi:[0,1]
    v_pk_add_f32 v[208:209], v[208:209], v[8:9] op_sel_hi:[1,0] neg_lo:[0,1] neg_hi:[0,1]
    v_pk_add_f32 v[210:211], v[210:211], v[8:9] op_sel_hi:[1,0] neg_lo:[0,1] neg_hi:[0,1]
    v_pk_add_f32 v[212:213], v[212:213], v[8:9] op_sel_hi:[1,0] neg_lo:[0,1] neg_hi:[0,1]
    v_pk_add_f32 v[214:215], v[214:215], v[8:9] op_sel_hi:[1,0] neg_lo:[0,1] neg_hi:[0,1]
    v_pk_add_f32 v[216:217], v[216:217], v[8:9] op_sel_hi:[1,0] neg_lo:[0,1] neg_hi:[0,1]
    v_pk_add_f32 v[218:219], v[218:219], v[8:9] op_sel_hi:[1,0] neg_lo:[0,1] neg_hi:[0,1]
    v_pk_add_f32 v[220:221], v[220:221], v[8:9] op_sel_hi:[1,0] neg_lo:[0,1] neg_hi:[0,1]
    v_pk_add_f32 v[222:223], v[222:223], v[8:9] op_sel_hi:[1,0] neg_lo:[0,1] neg_hi:[0,1]
    v_pk_add_f32 v[224:225], v[224:225], v[8:9] op_sel_hi:[1,0] neg_lo:[0,1] neg_hi:[0,1]
    v_pk_add_f32 v[226:227], v[226:227], v[8:9] op_sel_hi:[1,0] neg_lo:[0,1] neg_hi:[0,1]
    v_pk_add_f32 v[228:229], v[228:229], v[8:9] op_sel_hi:[1,0] neg_lo:[0,1] neg_hi:[0,1]
    v_pk_add_f32 v[230:231], v[230:231], v[8:9] op_sel_hi:[1,0] neg_lo:[0,1] neg_hi:[0,1]
    v_pk_add_f32 v[232:233], v[232:233], v[8:9] op_sel_hi:[1,0] neg_lo:[0,1] neg_hi:[0,1]
    v_pk_add_f32 v[234:235], v[234:235], v[8:9] op_sel_hi:[1,0] neg_lo:[0,1] neg_hi:[0,1]
    v_pk_add_f32 v[236:237], v[236:237], v[8:9] op_sel_hi:[1,0] neg_lo:[0,1] neg_hi:[0,1]
    v_pk_add_f32 v[238:239], v[238:239], v[8:9] op_sel_hi:[1,0] neg_lo:[0,1] neg_hi:[0,1]
    v_exp_f32 v188, v188
    v_exp_f32 v189, v189
    v_exp_f32 v190, v190
    v_exp_f32 v191, v191
    v_exp_f32 v192, v192
    v_exp_f32 v193, v193
    v_exp_f32 v194, v194
    v_exp_f32 v195, v195
    v_exp_f32 v196, v196
    v_exp_f32 v197, v197
    v_exp_f32 v198, v198
    v_exp_f32 v199, v199
    v_exp_f32 v200, v200
    v_exp_f32 v201, v201
    v_exp_f32 v202, v202
    v_exp_f32 v203, v203
    v_exp_f32 v204, v204
    v_exp_f32 v205, v205
    v_exp_f32 v206, v206
    v_exp_f32 v207, v207
    v_exp_f32 v208, v208
    v_exp_f32 v209, v209
    v_exp_f32 v210, v210
    v_exp_f32 v211, v211
    v_exp_f32 v212, v212
    v_exp_f32 v213, v213
    v_exp_f32 v214, v214
    v_exp_f32 v215, v215
    v_exp_f32 v216, v216
    v_exp_f32 v217, v217
    v_exp_f32 v218, v218
    v_exp_f32 v219, v219
    v_exp_f32 v220, v220
    v_exp_f32 v221, v221
    v_exp_f32 v222, v222
    v_exp_f32 v223, v223
    v_exp_f32 v224, v224
    v_exp_f32 v225, v225
    v_exp_f32 v226, v226
    v_exp_f32 v227, v227
    v_exp_f32 v228, v228
    v_exp_f32 v229, v229
    v_exp_f32 v230, v230
    v_exp_f32 v231, v231
    v_exp_f32 v232, v232
    v_exp_f32 v233, v233
    v_exp_f32 v234, v234
    v_exp_f32 v235, v235
    v_exp_f32 v236, v236
    v_exp_f32 v237, v237
    v_exp_f32 v238, v238
    v_exp_f32 v239, v239
    v_pk_add_f32 v[10:11], v[188:189], v[190:191]
    v_pk_add_f32 v[10:11], v[10:11], v[192:193]
    v_pk_add_f32 v[10:11], v[10:11], v[194:195]
    v_pk_add_f32 v[10:11], v[10:11], v[196:197]
    v_pk_add_f32 v[10:11], v[10:11], v[198:199]
    v_pk_add_f32 v[10:11], v[10:11], v[200:201]
    v_pk_add_f32 v[10:11], v[10:11], v[202:203]
    v_pk_add_f32 v[10:11], v[10:11], v[204:205]
    v_pk_add_f32 v[10:11], v[10:11], v[206:207]
    v_pk_add_f32 v[10:11], v[10:11], v[208:209]
    v_pk_add_f32 v[10:11], v[10:11], v[210:211]
    v_pk_add_f32 v[10:11], v[10:11], v[212:213]
    v_pk_add_f32 v[10:11], v[10:11], v[214:215]
    v_pk_add_f32 v[10:11], v[10:11], v[216:217]
    v_pk_add_f32 v[10:11], v[10:11], v[218:219]
    v_pk_add_f32 v[10:11], v[10:11], v[220:221]
    v_pk_add_f32 v[10:11], v[10:11], v[222:223]
    v_pk_add_f32 v[10:11], v[10:11], v[224:225]
    v_pk_add_f32 v[10:11], v[10:11], v[226:227]
    v_pk_add_f32 v[10:11], v[10:11], v[228:229]
    v_pk_add_f32 v[10:11], v[10:11], v[230:231]
    v_pk_add_f32 v[10:11], v[10:11], v[232:233]
    v_pk_add_f32 v[10:11], v[10:11], v[234:235]
    v_pk_add_f32 v[10:11], v[10:11], v[236:237]
    v_pk_add_f32 v[10:11], v[10:11], v[238:239]
    v_add_f32 v10, v10, v11
    v_mov_b32 v11, v10
    s_nop 1
    v_permlane32_swap_b32 v11, v10
    v_add_f32 v10, v10, v11
    v_rcp_f32 v10, v10
    v_cvt_pk_bf16_f32 v188, v188, v189
    v_cvt_pk_bf16_f32 v189, v190, v191
    v_cvt_pk_bf16_f32 v190, v192, v193
    v_cvt_pk_bf16_f32 v191, v194, v195
    v_cvt_pk_bf16_f32 v192, v196, v197
    v_cvt_pk_bf16_f32 v193, v198, v199
    v_cvt_pk_bf16_f32 v194, v200, v201
    v_cvt_pk_bf16_f32 v195, v202, v203
    v_cvt_pk_bf16_f32 v196, v204, v205
    v_cvt_pk_bf16_f32 v197, v206, v207
    v_cvt_pk_bf16_f32 v198, v208, v209
    v_cvt_pk_bf16_f32 v199, v210, v211
    v_cvt_pk_bf16_f32 v200, v212, v213
    v_cvt_pk_bf16_f32 v201, v214, v215
    v_cvt_pk_bf16_f32 v202, v216, v217
    v_cvt_pk_bf16_f32 v203, v218, v219
    v_cvt_pk_bf16_f32 v220, v220, v221
    v_cvt_pk_bf16_f32 v221, v222, v223
    v_cvt_pk_bf16_f32 v222, v224, v225
    v_cvt_pk_bf16_f32 v223, v226, v227
    v_cvt_pk_bf16_f32 v224, v228, v229
    v_cvt_pk_bf16_f32 v225, v230, v231
    v_cvt_pk_bf16_f32 v226, v232, v233
    v_cvt_pk_bf16_f32 v227, v234, v235
    v_cvt_pk_bf16_f32 v228, v236, v237
    v_cvt_pk_bf16_f32 v229, v238, v239
    v_mov_b32 v230, 0
    v_mov_b32 v231, 0
    v_mfma_f32_32x32x16_bf16 v[204:219], a[112:115], v[32:35], 0
    v_mfma_f32_32x32x16_bf16 v[204:219], a[116:119], v[36:39], v[204:219]
    v_mfma_f32_32x32x16_bf16 v[204:219], a[120:123], v[40:43], v[204:219]
    v_mfma_f32_32x32x16_bf16 v[204:219], a[124:127], v[44:47], v[204:219]
    v_mfma_f32_32x32x16_bf16 v[172:187], v[112:115], v[188:191], 0
    v_mfma_f32_32x32x16_bf16 v[172:187], v[116:119], v[192:195], v[172:187]
    v_mfma_f32_32x32x16_bf16 v[172:187], v[120:123], v[196:199], v[172:187]
    v_mfma_f32_32x32x16_bf16 v[172:187], v[124:127], v[200:203], v[172:187]
    v_mfma_f32_32x32x16_bf16 v[172:187], v[128:131], v[220:223], v[172:187]
    v_mfma_f32_32x32x16_bf16 v[172:187], v[132:135], v[224:227], v[172:187]
    v_mfma_f32_32x32x16_bf16 v[172:187], v[136:139], v[228:231], v[172:187]
    s_nop 11
    v_pk_fma_f32 v[172:173], v[172:173], v[10:11], v[204:205] op_sel_hi:[1,0,1]
    v_pk_fma_f32 v[174:175], v[174:175], v[10:11], v[206:207] op_sel_hi:[1,0,1]
    v_pk_fma_f32 v[176:177], v[176:177], v[10:11], v[208:209] op_sel_hi:[1,0,1]
    v_pk_fma_f32 v[178:179], v[178:179], v[10:11], v[210:211] op_sel_hi:[1,0,1]
    v_pk_fma_f32 v[180:181], v[180:181], v[10:11], v[212:213] op_sel_hi:[1,0,1]
    v_pk_fma_f32 v[182:183], v[182:183], v[10:11], v[214:215] op_sel_hi:[1,0,1]
    v_pk_fma_f32 v[184:185], v[184:185], v[10:11], v[216:217] op_sel_hi:[1,0,1]
    v_pk_fma_f32 v[186:187], v[186:187], v[10:11], v[218:219] op_sel_hi:[1,0,1]
    v_cvt_pk_bf16_f32 v172, v172, v173
    v_cvt_pk_bf16_f32 v173, v174, v175
    v_cvt_pk_bf16_f32 v174, v176, v177
    v_cvt_pk_bf16_f32 v175, v178, v179
    v_cvt_pk_bf16_f32 v176, v180, v181
    v_cvt_pk_bf16_f32 v177, v182, v183
    v_cvt_pk_bf16_f32 v178, v184, v185
    v_cvt_pk_bf16_f32 v179, v186, v187
    v_pk_max_i16 v172, v172, 0
    v_pk_max_i16 v173, v173, 0
    v_pk_max_i16 v174, v174, 0
    v_pk_max_i16 v175, v175, 0
    v_pk_max_i16 v176, v176, 0
    v_pk_max_i16 v177, v177, 0
    v_pk_max_i16 v178, v178, 0
    v_pk_max_i16 v179, v179, 0
    buffer_store_dwordx4 v[172:175], v2, s[28:31], s61 offen offset:64
    buffer_store_dwordx4 v[176:179], v2, s[28:31], s61 offen offset:96
    s_nop 1
    v_mfma_f32_32x32x16_bf16 v[172:187], a[16:19], v[48:51], 0
    v_mfma_f32_32x32x16_bf16 v[172:187], a[20:23], v[52:55], v[172:187]
    v_mfma_f32_32x32x16_bf16 v[172:187], a[24:27], v[56:59], v[172:187]
    v_mfma_f32_32x32x16_bf16 v[172:187], a[28:31], v[60:63], v[172:187]
    s_nop 11
    v_cvt_pk_bf16_f32 v172, v172, v173
    v_cvt_pk_bf16_f32 v173, v174, v175
    v_cvt_pk_bf16_f32 v174, v176, v177
    v_cvt_pk_bf16_f32 v175, v178, v179
    v_cvt_pk_bf16_f32 v176, v180, v181
    v_cvt_pk_bf16_f32 v177, v182, v183
    v_cvt_pk_bf16_f32 v178, v184, v185
    v_cvt_pk_bf16_f32 v179, v186, v187
    v_mfma_f32_32x32x16_bf16 v[188:203], v[80:83], v[172:175], 0
    s_nop 0
    v_mfma_f32_32x32x16_bf16 v[188:203], v[84:87], v[176:179], v[188:203]
    v_mfma_f32_32x32x16_bf16 v[204:219], v[88:91], v[172:175], 0
    v_mfma_f32_32x32x16_bf16 v[204:219], v[92:95], v[176:179], v[204:219]
    v_mfma_f32_32x32x16_bf16 v[220:235], v[96:99], v[172:175], 0
    v_mfma_f32_32x32x16_bf16 v[220:235], v[100:103], v[176:179], v[220:235]
    v_mfma_f32_32x32x16_bf16 v[236:251], v[104:107], v[172:175], 0
    v_mfma_f32_32x32x16_bf16 v[236:251], v[108:111], v[176:179], v[236:251]
    s_nop 11
    v_cndmask_b32 v236, v236, v5, s[56:57]
    v_cndmask_b32 v237, v237, v5, s[56:57]
    v_cndmask_b32 v238, v238, v5, s[56:57]
    v_cndmask_b32 v239, v239, v5, s[56:57]
    v_max3_f32 v8, v188, v189, v190
    v_max3_f32 v8, v8, v191, v192
    v_max3_f32 v8, v8, v193, v194
    v_max3_f32 v8, v8, v195, v196
    v_max3_f32 v8, v8, v197, v198
    v_max3_f32 v8, v8, v199, v200
    v_max3_f32 v8, v8, v201, v202
    v_max3_f32 v8, v8, v203, v204
    v_max3_f32 v8, v8, v205, v206
    v_max3_f32 v8, v8, v207, v208
    v_max3_f32 v8, v8, v209, v210
    v_max3_f32 v8, v8, v211, v212
    v_max3_f32 v8, v8, v213, v214
    v_max3_f32 v8, v8, v215, v216
    v_max3_f32 v8, v8, v217, v218
    v_max3_f32 v8, v8, v219, v220
    v_max3_f32 v8, v8, v221, v222
    v_max3_f32 v8, v8, v223, v224
    v_max3_f32 v8, v8, v225, v226
    v_max3_f32 v8, v8, v227, v228
    v_max3_f32 v8, v8, v229, v230
    v_max3_f32 v8, v8, v231, v232
    v_max3_f32 v8, v8, v233, v234
    v_max3_f32 v8, v8, v235, v236
    v_max3_f32 v8, v8, v237, v238
    v_max_f32 v8, v8, v239
    v_mov_b32 v9, v8
    s_nop 1
    v_permlane32_swap_b32 v9, v8
    v_max_f32 v8, v8, v9
    v_pk_add_f32 v[188:189], v[188:189], v[8:9] op_sel_hi:[1,0] neg_lo:[0,1] neg_hi:[0,1]
    v_pk_add_f32 v[190:191], v[190:191], v[8:9] op_sel_hi:[1,0] neg_lo:[0,1] neg_hi:[0,1]
    v_pk_add_f32 v[192:193], v[192:193], v[8:9] op_sel_hi:[1,0] neg_lo:[0,1] neg_hi:[0,1]
    v_pk_add_f32 v[194:195], v[194:195], v[8:9] op_sel_hi:[1,0] neg_lo:[0,1] neg_hi:[0,1]
    v_pk_add_f32 v[196:197], v[196:197], v[8:9] op_sel_hi:[1,0] neg_lo:[0,1] neg_hi:[0,1]
    v_pk_add_f32 v[198:199], v[198:199], v[8:9] op_sel_hi:[1,0] neg_lo:[0,1] neg_hi:[0,1]
    v_pk_add_f32 v[200:201], v[200:201], v[8:9] op_sel_hi:[1,0] neg_lo:[0,1] neg_hi:[0,1]
    v_pk_add_f32 v[202:203], v[202:203], v[8:9] op_sel_hi:[1,0] neg_lo:[0,1] neg_hi:[0,1]
    v_pk_add_f32 v[204:205], v[204:205], v[8:9] op_sel_hi:[1,0] neg_lo:[0,1] neg_hi:[0,1]
    v_pk_add_f32 v[206:207], v[206:207], v[8:9] op_sel_hi:[1,0] neg_lo:[0,1] neg_hi:[0,1]
    v_pk_add_f32 v[208:209], v[208:209], v[8:9] op_sel_hi:[1,0] neg_lo:[0,1] neg_hi:[0,1]
    v_pk_add_f32 v[210:211], v[210:211], v[8:9] op_sel_hi:[1,0] neg_lo:[0,1] neg_hi:[0,1]
    v_pk_add_f32 v[212:213], v[212:213], v[8:9] op_sel_hi:[1,0] neg_lo:[0,1] neg_hi:[0,1]
    v_pk_add_f32 v[214:215], v[214:215], v[8:9] op_sel_hi:[1,0] neg_lo:[0,1] neg_hi:[0,1]
    v_pk_add_f32 v[216:217], v[216:217], v[8:9] op_sel_hi:[1,0] neg_lo:[0,1] neg_hi:[0,1]
    v_pk_add_f32 v[218:219], v[218:219], v[8:9] op_sel_hi:[1,0] neg_lo:[0,1] neg_hi:[0,1]
    v_pk_add_f32 v[220:221], v[220:221], v[8:9] op_sel_hi:[1,0] neg_lo:[0,1] neg_hi:[0,1]
    v_pk_add_f32 v[222:223], v[222:223], v[8:9] op_sel_hi:[1,0] neg_lo:[0,1] neg_hi:[0,1]
    v_pk_add_f32 v[224:225], v[224:225], v[8:9] op_sel_hi:[1,0] neg_lo:[0,1] neg_hi:[0,1]
    v_pk_add_f32 v[226:227], v[226:227], v[8:9] op_sel_hi:[1,0] neg_lo:[0,1] neg_hi:[0,1]
    v_pk_add_f32 v[228:229], v[228:229], v[8:9] op_sel_hi:[1,0] neg_lo:[0,1] neg_hi:[0,1]
    v_pk_add_f32 v[230:231], v[230:231], v[8:9] op_sel_hi:[1,0] neg_lo:[0,1] neg_hi:[0,1]
    v_pk_add_f32 v[232:233], v[232:233], v[8:9] op_sel_hi:[1,0] neg_lo:[0,1] neg_hi:[0,1]
    v_pk_add_f32 v[234:235], v[234:235], v[8:9] op_sel_hi:[1,0] neg_lo:[0,1] neg_hi:[0,1]
    v_pk_add_f32 v[236:237], v[236:237], v[8:9] op_sel_hi:[1,0] neg_lo:[0,1] neg_hi:[0,1]
    v_pk_add_f32 v[238:239], v[238:239], v[8:9] op_sel_hi:[1,0] neg_lo:[0,1] neg_hi:[0,1]
    v_exp_f32 v188, v188
    v_exp_f32 v189, v189
    v_exp_f32 v190, v190
    v_exp_f32 v191, v191
    v_exp_f32 v192, v192
    v_exp_f32 v193, v193
    v_exp_f32 v194, v194
    v_exp_f32 v195, v195
    v_exp_f32 v196, v196
    v_exp_f32 v197, v197
    v_exp_f32 v198, v198
    v_exp_f32 v199, v199
    v_exp_f32 v200, v200
    v_exp_f32 v201, v201
    v_exp_f32 v202, v202
    v_exp_f32 v203, v203
    v_exp_f32 v204, v204
    v_exp_f32 v205, v205
    v_exp_f32 v206, v206
    v_exp_f32 v207, v207
    v_exp_f32 v208, v208
    v_exp_f32 v209, v209
    v_exp_f32 v210, v210
    v_exp_f32 v211, v211
    v_exp_f32 v212, v212
    v_exp_f32 v213, v213
    v_exp_f32 v214, v214
    v_exp_f32 v215, v215
    v_exp_f32 v216, v216
    v_exp_f32 v217, v217
    v_exp_f32 v218, v218
    v_exp_f32 v219, v219
    v_exp_f32 v220, v220
    v_exp_f32 v221, v221
    v_exp_f32 v222, v222
    v_exp_f32 v223, v223
    v_exp_f32 v224, v224
    v_exp_f32 v225, v225
    v_exp_f32 v226, v226
    v_exp_f32 v227, v227
    v_exp_f32 v228, v228
    v_exp_f32 v229, v229
    v_exp_f32 v230, v230
    v_exp_f32 v231, v231
    v_exp_f32 v232, v232
    v_exp_f32 v233, v233
    v_exp_f32 v234, v234
    v_exp_f32 v235, v235
    v_exp_f32 v236, v236
    v_exp_f32 v237, v237
    v_exp_f32 v238, v238
    v_exp_f32 v239, v239
    v_pk_add_f32 v[10:11], v[188:189], v[190:191]
    v_pk_add_f32 v[10:11], v[10:11], v[192:193]
    v_pk_add_f32 v[10:11], v[10:11], v[194:195]
    v_pk_add_f32 v[10:11], v[10:11], v[196:197]
    v_pk_add_f32 v[10:11], v[10:11], v[198:199]
    v_pk_add_f32 v[10:11], v[10:11], v[200:201]
    v_pk_add_f32 v[10:11], v[10:11], v[202:203]
    v_pk_add_f32 v[10:11], v[10:11], v[204:205]
    v_pk_add_f32 v[10:11], v[10:11], v[206:207]
    v_pk_add_f32 v[10:11], v[10:11], v[208:209]
    v_pk_add_f32 v[10:11], v[10:11], v[210:211]
    v_pk_add_f32 v[10:11], v[10:11], v[212:213]
    v_pk_add_f32 v[10:11], v[10:11], v[214:215]
    v_pk_add_f32 v[10:11], v[10:11], v[216:217]
    v_pk_add_f32 v[10:11], v[10:11], v[218:219]
    v_pk_add_f32 v[10:11], v[10:11], v[220:221]
    v_pk_add_f32 v[10:11], v[10:11], v[222:223]
    v_pk_add_f32 v[10:11], v[10:11], v[224:225]
    v_pk_add_f32 v[10:11], v[10:11], v[226:227]
    v_pk_add_f32 v[10:11], v[10:11], v[228:229]
    v_pk_add_f32 v[10:11], v[10:11], v[230:231]
    v_pk_add_f32 v[10:11], v[10:11], v[232:233]
    v_pk_add_f32 v[10:11], v[10:11], v[234:235]
    v_pk_add_f32 v[10:11], v[10:11], v[236:237]
    v_pk_add_f32 v[10:11], v[10:11], v[238:239]
    v_add_f32 v10, v10, v11
    v_mov_b32 v11, v10
    s_nop 1
    v_permlane32_swap_b32 v11, v10
    v_add_f32 v10, v10, v11
    v_rcp_f32 v10, v10
    v_cvt_pk_bf16_f32 v188, v188, v189
    v_cvt_pk_bf16_f32 v189, v190, v191
    v_cvt_pk_bf16_f32 v190, v192, v193
    v_cvt_pk_bf16_f32 v191, v194, v195
    v_cvt_pk_bf16_f32 v192, v196, v197
    v_cvt_pk_bf16_f32 v193, v198, v199
    v_cvt_pk_bf16_f32 v194, v200, v201
    v_cvt_pk_bf16_f32 v195, v202, v203
    v_cvt_pk_bf16_f32 v196, v204, v205
    v_cvt_pk_bf16_f32 v197, v206, v207
    v_cvt_pk_bf16_f32 v198, v208, v209
    v_cvt_pk_bf16_f32 v199, v210, v211
    v_cvt_pk_bf16_f32 v200, v212, v213
    v_cvt_pk_bf16_f32 v201, v214, v215
    v_cvt_pk_bf16_f32 v202, v216, v217
    v_cvt_pk_bf16_f32 v203, v218, v219
    v_cvt_pk_bf16_f32 v220, v220, v221
    v_cvt_pk_bf16_f32 v221, v222, v223
    v_cvt_pk_bf16_f32 v222, v224, v225
    v_cvt_pk_bf16_f32 v223, v226, v227
    v_cvt_pk_bf16_f32 v224, v228, v229
    v_cvt_pk_bf16_f32 v225, v230, v231
    v_cvt_pk_bf16_f32 v226, v232, v233
    v_cvt_pk_bf16_f32 v227, v234, v235
    v_cvt_pk_bf16_f32 v228, v236, v237
    v_cvt_pk_bf16_f32 v229, v238, v239
    v_mov_b32 v230, 0
    v_mov_b32 v231, 0
    v_mfma_f32_32x32x16_bf16 v[204:219], a[112:115], v[48:51], 0
    v_mfma_f32_32x32x16_bf16 v[204:219], a[116:119], v[52:55], v[204:219]
    v_mfma_f32_32x32x16_bf16 v[204:219], a[120:123], v[56:59], v[204:219]
    v_mfma_f32_32x32x16_bf16 v[204:219], a[124:127], v[60:63], v[204:219]
    v_mfma_f32_32x32x16_bf16 v[172:187], v[112:115], v[188:191], 0
    v_mfma_f32_32x32x16_bf16 v[172:187], v[116:119], v[192:195], v[172:187]
    v_mfma_f32_32x32x16_bf16 v[172:187], v[120:123], v[196:199], v[172:187]
    v_mfma_f32_32x32x16_bf16 v[172:187], v[124:127], v[200:203], v[172:187]
    v_mfma_f32_32x32x16_bf16 v[172:187], v[128:131], v[220:223], v[172:187]
    v_mfma_f32_32x32x16_bf16 v[172:187], v[132:135], v[224:227], v[172:187]
    v_mfma_f32_32x32x16_bf16 v[172:187], v[136:139], v[228:231], v[172:187]
    s_nop 11
    v_pk_fma_f32 v[172:173], v[172:173], v[10:11], v[204:205] op_sel_hi:[1,0,1]
    v_pk_fma_f32 v[174:175], v[174:175], v[10:11], v[206:207] op_sel_hi:[1,0,1]
    v_pk_fma_f32 v[176:177], v[176:177], v[10:11], v[208:209] op_sel_hi:[1,0,1]
    v_pk_fma_f32 v[178:179], v[178:179], v[10:11], v[210:211] op_sel_hi:[1,0,1]
    v_pk_fma_f32 v[180:181], v[180:181], v[10:11], v[212:213] op_sel_hi:[1,0,1]
    v_pk_fma_f32 v[182:183], v[182:183], v[10:11], v[214:215] op_sel_hi:[1,0,1]
    v_pk_fma_f32 v[184:185], v[184:185], v[10:11], v[216:217] op_sel_hi:[1,0,1]
    v_pk_fma_f32 v[186:187], v[186:187], v[10:11], v[218:219] op_sel_hi:[1,0,1]
    v_cvt_pk_bf16_f32 v172, v172, v173
    v_cvt_pk_bf16_f32 v173, v174, v175
    v_cvt_pk_bf16_f32 v174, v176, v177
    v_cvt_pk_bf16_f32 v175, v178, v179
    v_cvt_pk_bf16_f32 v176, v180, v181
    v_cvt_pk_bf16_f32 v177, v182, v183
    v_cvt_pk_bf16_f32 v178, v184, v185
    v_cvt_pk_bf16_f32 v179, v186, v187
    v_pk_max_i16 v172, v172, 0
    v_pk_max_i16 v173, v173, 0
    v_pk_max_i16 v174, v174, 0
    v_pk_max_i16 v175, v175, 0
    v_pk_max_i16 v176, v176, 0
    v_pk_max_i16 v177, v177, 0
    v_pk_max_i16 v178, v178, 0
    v_pk_max_i16 v179, v179, 0
    buffer_store_dwordx4 v[172:175], v2, s[28:31], s62 offen offset:64
    buffer_store_dwordx4 v[176:179], v2, s[28:31], s62 offen offset:96
    s_nop 1
    v_mfma_f32_32x32x16_bf16 v[172:187], a[16:19], v[64:67], 0
    v_mfma_f32_32x32x16_bf16 v[172:187], a[20:23], v[68:71], v[172:187]
    v_mfma_f32_32x32x16_bf16 v[172:187], a[24:27], v[72:75], v[172:187]
    v_mfma_f32_32x32x16_bf16 v[172:187], a[28:31], v[76:79], v[172:187]
    s_nop 11
    v_cvt_pk_bf16_f32 v172, v172, v173
    v_cvt_pk_bf16_f32 v173, v174, v175
    v_cvt_pk_bf16_f32 v174, v176, v177
    v_cvt_pk_bf16_f32 v175, v178, v179
    v_cvt_pk_bf16_f32 v176, v180, v181
    v_cvt_pk_bf16_f32 v177, v182, v183
    v_cvt_pk_bf16_f32 v178, v184, v185
    v_cvt_pk_bf16_f32 v179, v186, v187
    v_mfma_f32_32x32x16_bf16 v[188:203], v[80:83], v[172:175], 0
    s_nop 0
    v_mfma_f32_32x32x16_bf16 v[188:203], v[84:87], v[176:179], v[188:203]
    v_mfma_f32_32x32x16_bf16 v[204:219], v[88:91], v[172:175], 0
    v_mfma_f32_32x32x16_bf16 v[204:219], v[92:95], v[176:179], v[204:219]
    v_mfma_f32_32x32x16_bf16 v[220:235], v[96:99], v[172:175], 0
    v_mfma_f32_32x32x16_bf16 v[220:235], v[100:103], v[176:179], v[220:235]
    v_mfma_f32_32x32x16_bf16 v[236:251], v[104:107], v[172:175], 0
    v_mfma_f32_32x32x16_bf16 v[236:251], v[108:111], v[176:179], v[236:251]
    s_nop 11
    v_cndmask_b32 v236, v236, v5, s[56:57]
    v_cndmask_b32 v237, v237, v5, s[56:57]
    v_cndmask_b32 v238, v238, v5, s[56:57]
    v_cndmask_b32 v239, v239, v5, s[56:57]
    v_max3_f32 v8, v188, v189, v190
    v_max3_f32 v8, v8, v191, v192
    v_max3_f32 v8, v8, v193, v194
    v_max3_f32 v8, v8, v195, v196
    v_max3_f32 v8, v8, v197, v198
    v_max3_f32 v8, v8, v199, v200
    v_max3_f32 v8, v8, v201, v202
    v_max3_f32 v8, v8, v203, v204
    v_max3_f32 v8, v8, v205, v206
    v_max3_f32 v8, v8, v207, v208
    v_max3_f32 v8, v8, v209, v210
    v_max3_f32 v8, v8, v211, v212
    v_max3_f32 v8, v8, v213, v214
    v_max3_f32 v8, v8, v215, v216
    v_max3_f32 v8, v8, v217, v218
    v_max3_f32 v8, v8, v219, v220
    v_max3_f32 v8, v8, v221, v222
    v_max3_f32 v8, v8, v223, v224
    v_max3_f32 v8, v8, v225, v226
    v_max3_f32 v8, v8, v227, v228
    v_max3_f32 v8, v8, v229, v230
    v_max3_f32 v8, v8, v231, v232
    v_max3_f32 v8, v8, v233, v234
    v_max3_f32 v8, v8, v235, v236
    v_max3_f32 v8, v8, v237, v238
    v_max_f32 v8, v8, v239
    v_mov_b32 v9, v8
    s_nop 1
    v_permlane32_swap_b32 v9, v8
    v_max_f32 v8, v8, v9
    v_pk_add_f32 v[188:189], v[188:189], v[8:9] op_sel_hi:[1,0] neg_lo:[0,1] neg_hi:[0,1]
    v_pk_add_f32 v[190:191], v[190:191], v[8:9] op_sel_hi:[1,0] neg_lo:[0,1] neg_hi:[0,1]
    v_pk_add_f32 v[192:193], v[192:193], v[8:9] op_sel_hi:[1,0] neg_lo:[0,1] neg_hi:[0,1]
    v_pk_add_f32 v[194:195], v[194:195], v[8:9] op_sel_hi:[1,0] neg_lo:[0,1] neg_hi:[0,1]
    v_pk_add_f32 v[196:197], v[196:197], v[8:9] op_sel_hi:[1,0] neg_lo:[0,1] neg_hi:[0,1]
    v_pk_add_f32 v[198:199], v[198:199], v[8:9] op_sel_hi:[1,0] neg_lo:[0,1] neg_hi:[0,1]
    v_pk_add_f32 v[200:201], v[200:201], v[8:9] op_sel_hi:[1,0] neg_lo:[0,1] neg_hi:[0,1]
    v_pk_add_f32 v[202:203], v[202:203], v[8:9] op_sel_hi:[1,0] neg_lo:[0,1] neg_hi:[0,1]
    v_pk_add_f32 v[204:205], v[204:205], v[8:9] op_sel_hi:[1,0] neg_lo:[0,1] neg_hi:[0,1]
    v_pk_add_f32 v[206:207], v[206:207], v[8:9] op_sel_hi:[1,0] neg_lo:[0,1] neg_hi:[0,1]
    v_pk_add_f32 v[208:209], v[208:209], v[8:9] op_sel_hi:[1,0] neg_lo:[0,1] neg_hi:[0,1]
    v_pk_add_f32 v[210:211], v[210:211], v[8:9] op_sel_hi:[1,0] neg_lo:[0,1] neg_hi:[0,1]
    v_pk_add_f32 v[212:213], v[212:213], v[8:9] op_sel_hi:[1,0] neg_lo:[0,1] neg_hi:[0,1]
    v_pk_add_f32 v[214:215], v[214:215], v[8:9] op_sel_hi:[1,0] neg_lo:[0,1] neg_hi:[0,1]
    v_pk_add_f32 v[216:217], v[216:217], v[8:9] op_sel_hi:[1,0] neg_lo:[0,1] neg_hi:[0,1]
    v_pk_add_f32 v[218:219], v[218:219], v[8:9] op_sel_hi:[1,0] neg_lo:[0,1] neg_hi:[0,1]
    v_pk_add_f32 v[220:221], v[220:221], v[8:9] op_sel_hi:[1,0] neg_lo:[0,1] neg_hi:[0,1]
    v_pk_add_f32 v[222:223], v[222:223], v[8:9] op_sel_hi:[1,0] neg_lo:[0,1] neg_hi:[0,1]
    v_pk_add_f32 v[224:225], v[224:225], v[8:9] op_sel_hi:[1,0] neg_lo:[0,1] neg_hi:[0,1]
    v_pk_add_f32 v[226:227], v[226:227], v[8:9] op_sel_hi:[1,0] neg_lo:[0,1] neg_hi:[0,1]
    v_pk_add_f32 v[228:229], v[228:229], v[8:9] op_sel_hi:[1,0] neg_lo:[0,1] neg_hi:[0,1]
    v_pk_add_f32 v[230:231], v[230:231], v[8:9] op_sel_hi:[1,0] neg_lo:[0,1] neg_hi:[0,1]
    v_pk_add_f32 v[232:233], v[232:233], v[8:9] op_sel_hi:[1,0] neg_lo:[0,1] neg_hi:[0,1]
    v_pk_add_f32 v[234:235], v[234:235], v[8:9] op_sel_hi:[1,0] neg_lo:[0,1] neg_hi:[0,1]
    v_pk_add_f32 v[236:237], v[236:237], v[8:9] op_sel_hi:[1,0] neg_lo:[0,1] neg_hi:[0,1]
    v_pk_add_f32 v[238:239], v[238:239], v[8:9] op_sel_hi:[1,0] neg_lo:[0,1] neg_hi:[0,1]
    v_exp_f32 v188, v188
    v_exp_f32 v189, v189
    v_exp_f32 v190, v190
    v_exp_f32 v191, v191
    v_exp_f32 v192, v192
    v_exp_f32 v193, v193
    v_exp_f32 v194, v194
    v_exp_f32 v195, v195
    v_exp_f32 v196, v196
    v_exp_f32 v197, v197
    v_exp_f32 v198, v198
    v_exp_f32 v199, v199
    v_exp_f32 v200, v200
    v_exp_f32 v201, v201
    v_exp_f32 v202, v202
    v_exp_f32 v203, v203
    v_exp_f32 v204, v204
    v_exp_f32 v205, v205
    v_exp_f32 v206, v206
    v_exp_f32 v207, v207
    v_exp_f32 v208, v208
    v_exp_f32 v209, v209
    v_exp_f32 v210, v210
    v_exp_f32 v211, v211
    v_exp_f32 v212, v212
    v_exp_f32 v213, v213
    v_exp_f32 v214, v214
    v_exp_f32 v215, v215
    v_exp_f32 v216, v216
    v_exp_f32 v217, v217
    v_exp_f32 v218, v218
    v_exp_f32 v219, v219
    v_exp_f32 v220, v220
    v_exp_f32 v221, v221
    v_exp_f32 v222, v222
    v_exp_f32 v223, v223
    v_exp_f32 v224, v224
    v_exp_f32 v225, v225
    v_exp_f32 v226, v226
    v_exp_f32 v227, v227
    v_exp_f32 v228, v228
    v_exp_f32 v229, v229
    v_exp_f32 v230, v230
    v_exp_f32 v231, v231
    v_exp_f32 v232, v232
    v_exp_f32 v233, v233
    v_exp_f32 v234, v234
    v_exp_f32 v235, v235
    v_exp_f32 v236, v236
    v_exp_f32 v237, v237
    v_exp_f32 v238, v238
    v_exp_f32 v239, v239
    v_pk_add_f32 v[10:11], v[188:189], v[190:191]
    v_pk_add_f32 v[10:11], v[10:11], v[192:193]
    v_pk_add_f32 v[10:11], v[10:11], v[194:195]
    v_pk_add_f32 v[10:11], v[10:11], v[196:197]
    v_pk_add_f32 v[10:11], v[10:11], v[198:199]
    v_pk_add_f32 v[10:11], v[10:11], v[200:201]
    v_pk_add_f32 v[10:11], v[10:11], v[202:203]
    v_pk_add_f32 v[10:11], v[10:11], v[204:205]
    v_pk_add_f32 v[10:11], v[10:11], v[206:207]
    v_pk_add_f32 v[10:11], v[10:11], v[208:209]
    v_pk_add_f32 v[10:11], v[10:11], v[210:211]
    v_pk_add_f32 v[10:11], v[10:11], v[212:213]
    v_pk_add_f32 v[10:11], v[10:11], v[214:215]
    v_pk_add_f32 v[10:11], v[10:11], v[216:217]
    v_pk_add_f32 v[10:11], v[10:11], v[218:219]
    v_pk_add_f32 v[10:11], v[10:11], v[220:221]
    v_pk_add_f32 v[10:11], v[10:11], v[222:223]
    v_pk_add_f32 v[10:11], v[10:11], v[224:225]
    v_pk_add_f32 v[10:11], v[10:11], v[226:227]
    v_pk_add_f32 v[10:11], v[10:11], v[228:229]
    v_pk_add_f32 v[10:11], v[10:11], v[230:231]
    v_pk_add_f32 v[10:11], v[10:11], v[232:233]
    v_pk_add_f32 v[10:11], v[10:11], v[234:235]
    v_pk_add_f32 v[10:11], v[10:11], v[236:237]
    v_pk_add_f32 v[10:11], v[10:11], v[238:239]
    v_add_f32 v10, v10, v11
    v_mov_b32 v11, v10
    s_nop 1
    v_permlane32_swap_b32 v11, v10
    v_add_f32 v10, v10, v11
    v_rcp_f32 v10, v10
    v_cvt_pk_bf16_f32 v188, v188, v189
    v_cvt_pk_bf16_f32 v189, v190, v191
    v_cvt_pk_bf16_f32 v190, v192, v193
    v_cvt_pk_bf16_f32 v191, v194, v195
    v_cvt_pk_bf16_f32 v192, v196, v197
    v_cvt_pk_bf16_f32 v193, v198, v199
    v_cvt_pk_bf16_f32 v194, v200, v201
    v_cvt_pk_bf16_f32 v195, v202, v203
    v_cvt_pk_bf16_f32 v196, v204, v205
    v_cvt_pk_bf16_f32 v197, v206, v207
    v_cvt_pk_bf16_f32 v198, v208, v209
    v_cvt_pk_bf16_f32 v199, v210, v211
    v_cvt_pk_bf16_f32 v200, v212, v213
    v_cvt_pk_bf16_f32 v201, v214, v215
    v_cvt_pk_bf16_f32 v202, v216, v217
    v_cvt_pk_bf16_f32 v203, v218, v219
    v_cvt_pk_bf16_f32 v220, v220, v221
    v_cvt_pk_bf16_f32 v221, v222, v223
    v_cvt_pk_bf16_f32 v222, v224, v225
    v_cvt_pk_bf16_f32 v223, v226, v227
    v_cvt_pk_bf16_f32 v224, v228, v229
    v_cvt_pk_bf16_f32 v225, v230, v231
    v_cvt_pk_bf16_f32 v226, v232, v233
    v_cvt_pk_bf16_f32 v227, v234, v235
    v_cvt_pk_bf16_f32 v228, v236, v237
    v_cvt_pk_bf16_f32 v229, v238, v239
    v_mov_b32 v230, 0
    v_mov_b32 v231, 0
    v_mfma_f32_32x32x16_bf16 v[204:219], a[112:115], v[64:67], 0
    v_mfma_f32_32x32x16_bf16 v[204:219], a[116:119], v[68:71], v[204:219]
    v_mfma_f32_32x32x16_bf16 v[204:219], a[120:123], v[72:75], v[204:219]
    v_mfma_f32_32x32x16_bf16 v[204:219], a[124:127], v[76:79], v[204:219]
    v_mfma_f32_32x32x16_bf16 v[172:187], v[112:115], v[188:191], 0
    v_mfma_f32_32x32x16_bf16 v[172:187], v[116:119], v[192:195], v[172:187]
    v_mfma_f32_32x32x16_bf16 v[172:187], v[120:123], v[196:199], v[172:187]
    v_mfma_f32_32x32x16_bf16 v[172:187], v[124:127], v[200:203], v[172:187]
    v_mfma_f32_32x32x16_bf16 v[172:187], v[128:131], v[220:223], v[172:187]
    v_mfma_f32_32x32x16_bf16 v[172:187], v[132:135], v[224:227], v[172:187]
    v_mfma_f32_32x32x16_bf16 v[172:187], v[136:139], v[228:231], v[172:187]
    s_nop 11
    v_pk_fma_f32 v[172:173], v[172:173], v[10:11], v[204:205] op_sel_hi:[1,0,1]
    v_pk_fma_f32 v[174:175], v[174:175], v[10:11], v[206:207] op_sel_hi:[1,0,1]
    v_pk_fma_f32 v[176:177], v[176:177], v[10:11], v[208:209] op_sel_hi:[1,0,1]
    v_pk_fma_f32 v[178:179], v[178:179], v[10:11], v[210:211] op_sel_hi:[1,0,1]
    v_pk_fma_f32 v[180:181], v[180:181], v[10:11], v[212:213] op_sel_hi:[1,0,1]
    v_pk_fma_f32 v[182:183], v[182:183], v[10:11], v[214:215] op_sel_hi:[1,0,1]
    v_pk_fma_f32 v[184:185], v[184:185], v[10:11], v[216:217] op_sel_hi:[1,0,1]
    v_pk_fma_f32 v[186:187], v[186:187], v[10:11], v[218:219] op_sel_hi:[1,0,1]
    v_cvt_pk_bf16_f32 v172, v172, v173
    v_cvt_pk_bf16_f32 v173, v174, v175
    v_cvt_pk_bf16_f32 v174, v176, v177
    v_cvt_pk_bf16_f32 v175, v178, v179
    v_cvt_pk_bf16_f32 v176, v180, v181
    v_cvt_pk_bf16_f32 v177, v182, v183
    v_cvt_pk_bf16_f32 v178, v184, v185
    v_cvt_pk_bf16_f32 v179, v186, v187
    v_pk_max_i16 v172, v172, 0
    v_pk_max_i16 v173, v173, 0
    v_pk_max_i16 v174, v174, 0
    v_pk_max_i16 v175, v175, 0
    v_pk_max_i16 v176, v176, 0
    v_pk_max_i16 v177, v177, 0
    v_pk_max_i16 v178, v178, 0
    v_pk_max_i16 v179, v179, 0
    buffer_store_dwordx4 v[172:175], v3, s[28:31], s63 offen offset:64
    buffer_store_dwordx4 v[176:179], v3, s[28:31], s63 offen offset:96
    s_add_u32 s58, s58, 12800
    s_add_u32 s59, s59, 1
    s_cmp_lt_u32 s59, 4
    s_nop 15
    s_cbranch_scc1 L_sbatch
    s_endpgm
.section .rodata,"a"
.p2align 6
.amdhsa_kernel standalone__attention_interact_autoint__recsys_kernel
  .amdhsa_next_free_vgpr 512
  .amdhsa_next_free_sgpr 72
  .amdhsa_accum_offset 256
  .amdhsa_group_segment_fixed_size 0
  .amdhsa_kernarg_size 64
  .amdhsa_user_sgpr_count 2
  .amdhsa_user_sgpr_kernarg_segment_ptr 1
  .amdhsa_system_sgpr_workgroup_id_x 1
.end_amdhsa_kernel
```
